```python
import torch

def _softmax(x, axis=-1):
    return torch.softmax(x, dim=axis)
def _gelu(x):
    return torch.nn.functional.gelu(x, approximate="tanh")
def _silu(x):
    return torch.nn.functional.silu(x)
def _sigmoid(x):
    return torch.sigmoid(x)
def _layernorm(x, axis=-1, eps=1e-5):
    m = x.mean(dim=axis, keepdim=True)
    v = x.var(dim=axis, keepdim=True, unbiased=False)
    return (x - m) / torch.sqrt(v + eps)
def _scatter_add(tgt, idx, src, axis=0):
    return tgt.clone().index_add_(axis, idx, src)
def _segment_sum(src, seg, n):
    out = torch.zeros((n,) + src.shape[1:], dtype=src.dtype)
    return out.index_add_(0, seg, src)
def _pad(x, pw):
    flat = tuple(v for pair in reversed(pw) for v in pair)
    return torch.nn.functional.pad(x, flat)

kernel_name = 'parallel_sum__sliding_block_cached__mixer_channel_mlp__decode'

def setup_inputs():

    _w = (lambda a: (lambda t: t.to(torch.bfloat16) if t.is_floating_point() else t)(torch.as_tensor(a)))
    def _A_setup():
        B, Sq, D = 1, 1, 512
        Hq, Hkv, Sk, Dh = 32, 32, 16384, 128
        assert Hq % Hkv == 0, (Hq, Hkv)
        return {
            "x": _w((lambda *s: torch.randn(*s, dtype=torch.bfloat16) * 0.05)(B, Sq, D)),
            "k_cache": _w((lambda *s: torch.randn(*s, dtype=torch.bfloat16) * 3.2)(B, Hkv, Sk, Dh)),
            "v_cache": _w((lambda *s: torch.randn(*s, dtype=torch.bfloat16) * 0.4)(B, Hkv, Sk, Dh)),
            "wq": _w((lambda *s: torch.randn(*s, dtype=torch.bfloat16) * 3.2)(D, Hq * Dh) * (D ** -0.5)),
            "wo": _w((lambda *s: torch.randn(*s, dtype=torch.bfloat16) * 0.4)(Hq * Dh, D) * ((Hq * Dh) ** -0.5)),
        }
    _A_in = _A_setup()

    def _B_setup():
        B, S, D, F = 1, 1, 512, 1376
        return {
            "x": _w((lambda *s: torch.randn(*s, dtype=torch.bfloat16) * 0.05)(B, S, D)),
            "w1": _w((lambda *s: torch.randn(*s, dtype=torch.bfloat16) * 1.6)(D, F) * (D ** -0.5)),
            "b1": _w((lambda *s: torch.randn(*s, dtype=torch.bfloat16) * 1.6)(F)),
            "w2": _w((lambda *s: torch.randn(*s, dtype=torch.bfloat16) * 0.1)(F, D) * (F ** -0.5)),
            "b2": _w((lambda *s: torch.randn(*s, dtype=torch.bfloat16) * 0.1)(D)),
        }
    _B_in = _B_setup()

    return {
        "A_x": _A_in["x"],
        "A_k_cache": _A_in["k_cache"],
        "A_v_cache": _A_in["v_cache"],
        "A_wq": _A_in["wq"],
        "A_wo": _A_in["wo"],
        "B_x": _B_in["x"],
        "B_w1": _B_in["w1"],
        "B_b1": _B_in["b1"],
        "B_w2": _B_in["w2"],
        "B_b2": _B_in["b2"],
    }

def reference(A_x, A_k_cache, A_v_cache, A_wq, A_wo, B_x, B_w1, B_b1, B_w2, B_b2):
    def _A_ref(x, k_cache, v_cache, wq, wo):
        B, Sq, D = x.shape
        Hq, Dh = 32, 128
        Hkv, Sk = k_cache.shape[1], k_cache.shape[2]
        W = min(4096, max(256, Sk // 4))
        rep = Hq // Hkv
        q = (lambda x, *d: x.permute(*d))((x @ wq).reshape(B, Sq, Hq, Dh), 0, 2, 1, 3)
        k = (lambda x, n, axis: torch.repeat_interleave(x, n, dim=axis))(k_cache[:, :, Sk - W:, :], rep, axis=1)
        v = (lambda x, n, axis: torch.repeat_interleave(x, n, dim=axis))(v_cache[:, :, Sk - W:, :], rep, axis=1)
        scores = torch.einsum("bhqd,bhkd->bhqk", q, k) * (Dh ** -0.5)
        p = _softmax(scores, axis=-1)
        o = torch.einsum("bhqk,bhkd->bhqd", p, v)
        return (lambda x, *d: x.permute(*d))(o, 0, 2, 1, 3).reshape(B, Sq, Hq * Dh) @ wo

    def _B_ref(x, w1, b1, w2, b2):
        y = _layernorm(x, axis=-1)
        h = _gelu(torch.einsum("bsd,df->bsf", y, w1) + b1)
        return torch.einsum("bsf,fd->bsd", h, w2) + b2

    x = A_x
    xn = _layernorm(x, axis=-1)
    return x + _A_ref(xn, A_k_cache, A_v_cache, A_wq, A_wo) + _B_ref(xn, B_w1, B_b1, B_w2, B_b2)
```

```asm
; @launch grid=(256,1,1) block=(640,1,1) lds=9216
.amdgcn_target "amdgcn-amd-amdhsa--gfx950"
.text
.globl parallel_sum__sliding_block_cached__mixer_channel_mlp__decode_kernel
.p2align 8
.type parallel_sum__sliding_block_cached__mixer_channel_mlp__decode_kernel,@function
parallel_sum__sliding_block_cached__mixer_channel_mlp__decode_kernel:
    s_cmpk_ge_u32 s2, 0x100
    s_cbranch_scc1 L_end
    s_load_dwordx16 s[4:19], s[0:1], 0
    s_cmp_ge_u32 s2, 16
    s_cbranch_scc1 L_nocpf
    s_getpc_b64 s[34:35]
L_pc:
    s_and_b32 s36, s2, 8
    s_lshl_b32 s36, s36, 8
    v_lshl_add_u32 v1, v0, 4, s36
    v_min_u32 v1, L_end-L_pc-12, v1
    global_load_dwordx4 v[64:67], v1, s[34:35]
L_nocpf:
    v_lshrrev_b32 v1, 6, v0
    v_and_b32 v0, 63, v0
    v_readfirstlane_b32 s30, v1
    v_lshlrev_b32 v2, 2, v0
    v_mov_b32 v3, 0
    ds_write_b32 v2, v3
    s_and_b32 s47, s2, 7
    s_lshr_b32 s46, s2, 3
    s_and_b32 s34, s46, 3
    s_lshl2_add_u32 s31, s47, s34
    s_lshr_b32 s32, s2, 5
    s_barrier
    v_and_b32 v1, 15, v0
    v_lshrrev_b32 v2, 4, v0
    s_sub_u32 s30, s30, 2
    s_cbranch_scc1 L_helpers
    s_lshl2_add_u32 s34, s31, 3
    s_lshl_b32 s34, s34, 8
    s_xor_b32 s35, s32, s30
    s_or_b32 s34, s34, s35
    s_and_b32 s35, s30, 3
    s_lshl_b32 s35, s35, 6
    s_or_b32 s34, s34, s35
    s_and_b32 s35, s30, 4
    s_lshl3_add_u32 s34, s35, s34
    s_lshl_b32 s34, s34, 12
    v_lshrrev_b32 v3, 2, v1
    v_lshl_or_b32 v3, v3, 2, v2
    v_and_b32 v4, 3, v1
    v_lshl_or_b32 v3, v3, 2, v4
    v_lshl_or_b32 v3, v3, 4, s34
    s_waitcnt lgkmcnt(0)
    global_load_dwordx4 v[8:11], v3, s[6:7] offset:0 nt
    s_mov_b32 s35, 0xa000
    global_load_dwordx4 v[12:15], v3, s[6:7] offset:1024 nt
    v_xor_b32 v136, s35, v3
    global_load_dwordx4 v[16:19], v3, s[6:7] offset:2048 nt
    s_lshl_b32 s36, s35, 1
    global_load_dwordx4 v[20:23], v3, s[6:7] offset:3072 nt
    v_mov_b32 v167, 0
    global_load_dwordx4 v[24:27], v136, s[6:7] offset:0 nt
    v_xor_b32 v137, s36, v3
    global_load_dwordx4 v[28:31], v136, s[6:7] offset:1024 nt
    v_xor_b32 v138, s36, v136
    global_load_dwordx4 v[32:35], v136, s[6:7] offset:2048 nt
    v_mul_u32_u24 v5, s35, v2
    global_load_dwordx4 v[36:39], v136, s[6:7] offset:3072 nt
    v_mov_b32 v167, 0
    global_load_dwordx4 v[40:43], v137, s[6:7] offset:0 nt
    v_lshl_or_b32 v4, v1, 4, s34
    global_load_dwordx4 v[44:47], v137, s[6:7] offset:1024 nt
    v_xor_b32 v4, v4, v5
    global_load_dwordx4 v[48:51], v137, s[6:7] offset:2048 nt
    v_mov_b32 v167, 0
    global_load_dwordx4 v[52:55], v137, s[6:7] offset:3072 nt
    v_mov_b32 v167, 0
    global_load_dwordx4 v[56:59], v138, s[6:7] offset:0 nt
    v_mov_b32 v167, 0
    global_load_dwordx4 v[60:63], v138, s[6:7] offset:1024 nt
    v_mov_b32 v167, 0
    global_load_dwordx4 v[64:67], v138, s[6:7] offset:2048 nt
    v_mov_b32 v167, 0
    global_load_dwordx4 v[68:71], v138, s[6:7] offset:3072 nt
    v_mov_b32 v167, 0
    global_load_dwordx4 v[72:75], v4, s[8:9] offset:0 nt
    v_mov_b32 v167, 0
    global_load_dwordx4 v[76:79], v4, s[8:9] offset:1024 nt
    v_mov_b32 v167, 0
    global_load_dwordx4 v[80:83], v4, s[8:9] offset:2048 nt
    v_mov_b32 v167, 0
    global_load_dwordx4 v[84:87], v4, s[8:9] offset:3072 nt
    v_mov_b32 v167, 0
    global_load_dwordx4 v[88:91], v4, s[8:9] offset:256 nt
    v_mov_b32 v167, 0
    global_load_dwordx4 v[92:95], v4, s[8:9] offset:1280 nt
    v_mov_b32 v167, 0
    global_load_dwordx4 v[96:99], v4, s[8:9] offset:2304 nt
    v_mov_b32 v167, 0
    global_load_dwordx4 v[100:103], v4, s[8:9] offset:3328 nt
    v_mov_b32 v167, 0
    global_load_dwordx4 v[104:107], v4, s[8:9] offset:512 nt
    v_mov_b32 v167, 0
    global_load_dwordx4 v[108:111], v4, s[8:9] offset:1536 nt
    v_mov_b32 v167, 0
    global_load_dwordx4 v[112:115], v4, s[8:9] offset:2560 nt
    v_mov_b32 v167, 0
    global_load_dwordx4 v[116:119], v4, s[8:9] offset:3584 nt
    v_mov_b32 v167, 0
    global_load_dwordx4 v[120:123], v4, s[8:9] offset:768 nt
    v_mov_b32 v167, 0
    global_load_dwordx4 v[124:127], v4, s[8:9] offset:1792 nt
    v_mov_b32 v167, 0
    global_load_dwordx4 v[128:131], v4, s[8:9] offset:2816 nt
    v_mov_b32 v167, 0
    global_load_dwordx4 v[132:135], v4, s[8:9] offset:3840 nt
    v_mov_b32 v150, 1
    v_mov_b32 v151, 0
    s_mov_b64 exec, 1
    ds_add_u32 v151, v150 offset:12
    s_mov_b64 exec, -1
    v_and_b32 v3, 1, v1
    v_lshlrev_b32 v3, 4, v3
    s_mov_b32 s34, 0xffff
    v_lshlrev_b32 v3, v3, s34
    s_mov_b32 s34, 0x30003
    s_mov_b32 s35, 0x30003
    v_cndmask_b32 v4, 0, v3, s[34:35]
    s_mov_b32 s34, 0xc000c
    s_mov_b32 s35, 0xc000c
    v_cndmask_b32 v5, 0, v3, s[34:35]
    s_mov_b32 s34, 0x300030
    s_mov_b32 s35, 0x300030
    v_cndmask_b32 v6, 0, v3, s[34:35]
    s_mov_b32 s34, 0xc000c0
    s_mov_b32 s35, 0xc000c0
    v_cndmask_b32 v7, 0, v3, s[34:35]
    s_mov_b32 s40, 0
L_wq:
    s_sleep 1
    v_mov_b32 v3, 0
    ds_read_b32 v3, v3 offset:0
    s_add_u32 s40, s40, 1
    s_waitcnt lgkmcnt(0)
    v_readfirstlane_b32 s36, v3
    s_cmp_ge_u32 s40, 16777216
    s_cbranch_scc1 L_wq_x
    s_cmp_lt_u32 s36, 1
    s_cbranch_scc1 L_wq
L_wq_x:
    v_and_b32 v3, 3, v1
    v_lshl_add_u32 v3, v2, 2, v3
    v_lshlrev_b32 v3, 4, v3
    ds_read_b128 v[152:155], v3 offset:256
    s_waitcnt lgkmcnt(0)
    s_mov_b32 s34, 0xf000f
    s_mov_b32 s35, 0xf000f
    v_cndmask_b32 v136, 0, v152, s[34:35]
    v_cndmask_b32 v137, 0, v153, s[34:35]
    v_cndmask_b32 v138, 0, v154, s[34:35]
    v_cndmask_b32 v139, 0, v155, s[34:35]
    s_mov_b32 s34, 0xf000f0
    s_mov_b32 s35, 0xf000f0
    v_cndmask_b32 v140, 0, v152, s[34:35]
    v_cndmask_b32 v141, 0, v153, s[34:35]
    v_cndmask_b32 v142, 0, v154, s[34:35]
    v_cndmask_b32 v143, 0, v155, s[34:35]
    s_mov_b32 s34, 0xf000f00
    s_mov_b32 s35, 0xf000f00
    v_cndmask_b32 v144, 0, v152, s[34:35]
    v_cndmask_b32 v145, 0, v153, s[34:35]
    v_cndmask_b32 v146, 0, v154, s[34:35]
    v_cndmask_b32 v147, 0, v155, s[34:35]
    s_mov_b32 s34, 0xf000f000
    s_mov_b32 s35, 0xf000f000
    v_cndmask_b32 v148, 0, v152, s[34:35]
    v_cndmask_b32 v149, 0, v153, s[34:35]
    v_cndmask_b32 v150, 0, v154, s[34:35]
    v_cndmask_b32 v151, 0, v155, s[34:35]
    s_waitcnt vmcnt(31)
    v_mfma_f32_16x16x32_bf16 v[152:155], v[136:139], v[8:11], 0
    s_waitcnt vmcnt(30)
    v_mfma_f32_16x16x32_bf16 v[156:159], v[136:139], v[12:15], 0
    s_waitcnt vmcnt(29)
    v_mfma_f32_16x16x32_bf16 v[160:163], v[136:139], v[16:19], 0
    s_waitcnt vmcnt(28)
    v_mfma_f32_16x16x32_bf16 v[164:167], v[136:139], v[20:23], 0
    s_waitcnt vmcnt(27)
    v_mfma_f32_16x16x32_bf16 v[152:155], v[140:143], v[24:27], v[152:155]
    s_waitcnt vmcnt(26)
    v_mfma_f32_16x16x32_bf16 v[156:159], v[140:143], v[28:31], v[156:159]
    s_waitcnt vmcnt(25)
    v_mfma_f32_16x16x32_bf16 v[160:163], v[140:143], v[32:35], v[160:163]
    s_waitcnt vmcnt(24)
    v_mfma_f32_16x16x32_bf16 v[164:167], v[140:143], v[36:39], v[164:167]
    s_waitcnt vmcnt(23)
    v_mfma_f32_16x16x32_bf16 v[152:155], v[144:147], v[40:43], v[152:155]
    s_waitcnt vmcnt(22)
    v_mfma_f32_16x16x32_bf16 v[156:159], v[144:147], v[44:47], v[156:159]
    s_waitcnt vmcnt(21)
    v_mfma_f32_16x16x32_bf16 v[160:163], v[144:147], v[48:51], v[160:163]
    s_waitcnt vmcnt(20)
    v_mfma_f32_16x16x32_bf16 v[164:167], v[144:147], v[52:55], v[164:167]
    s_waitcnt vmcnt(19)
    v_mfma_f32_16x16x32_bf16 v[152:155], v[148:151], v[56:59], v[152:155]
    s_waitcnt vmcnt(18)
    v_mfma_f32_16x16x32_bf16 v[156:159], v[148:151], v[60:63], v[156:159]
    s_waitcnt vmcnt(17)
    v_mfma_f32_16x16x32_bf16 v[160:163], v[148:151], v[64:67], v[160:163]
    s_waitcnt vmcnt(16)
    v_mfma_f32_16x16x32_bf16 v[164:167], v[148:151], v[68:71], v[164:167]
    s_mov_b32 s42, 0xaaaaaaaa
    s_mov_b32 s43, 0xaaaaaaaa
    s_mov_b32 s44, 0xcccccccc
    s_mov_b32 s45, 0xcccccccc
    v_cndmask_b32 v152, v152, v153, s[42:43]
    v_cndmask_b32 v154, v154, v155, s[42:43]
    v_cndmask_b32 v136, v152, v154, s[44:45]
    v_cndmask_b32 v156, v156, v157, s[42:43]
    v_cndmask_b32 v158, v158, v159, s[42:43]
    v_cndmask_b32 v137, v156, v158, s[44:45]
    v_cndmask_b32 v160, v160, v161, s[42:43]
    v_cndmask_b32 v162, v162, v163, s[42:43]
    v_cndmask_b32 v138, v160, v162, s[44:45]
    v_cndmask_b32 v164, v164, v165, s[42:43]
    v_cndmask_b32 v166, v166, v167, s[42:43]
    v_cndmask_b32 v139, v164, v166, s[44:45]
    v_cndmask_b32 v140, v136, v137, s[42:43]
    v_cndmask_b32 v141, v137, v136, s[42:43]
    v_cndmask_b32 v142, v138, v139, s[42:43]
    v_cndmask_b32 v143, v139, v138, s[42:43]
    v_add_f32_dpp v140, v141, v140 quad_perm:[1,0,3,2] row_mask:0xf bank_mask:0xf
    s_nop 0
    v_add_f32_dpp v142, v143, v142 quad_perm:[1,0,3,2] row_mask:0xf bank_mask:0xf
    v_cndmask_b32 v144, v140, v142, s[44:45]
    v_cndmask_b32 v145, v142, v140, s[44:45]
    s_nop 1
    v_add_f32_dpp v144, v145, v144 quad_perm:[2,3,0,1] row_mask:0xf bank_mask:0xf
    v_cvt_pk_bf16_f32 v144, v144, v144
    v_lshlrev_b32 v144, 16, v144
    v_mul_f32 v144, 0x3db504f3, v144
    v_cvt_pk_bf16_f32 v144, v144, v144
    v_lshlrev_b32 v144, 16, v144
    v_mov_b32 v145, v144
    s_nop 1
    v_max_f32_dpp v145, v145, v145 row_ror:8 row_mask:0xf bank_mask:0xf
    s_nop 1
    v_max_f32_dpp v145, v145, v145 row_ror:4 row_mask:0xf bank_mask:0xf
    s_nop 1
    v_max_f32_dpp v145, v145, v145 row_ror:2 row_mask:0xf bank_mask:0xf
    s_nop 1
    v_max_f32_dpp v145, v145, v145 row_ror:1 row_mask:0xf bank_mask:0xf
    s_nop 1
    v_max_f32_dpp v145, v145, v145 row_bcast:15 row_mask:0xa bank_mask:0xf
    s_nop 1
    v_max_f32_dpp v145, v145, v145 row_bcast:31 row_mask:0xc bank_mask:0xf
    s_nop 0
    v_readlane_b32 s36, v145, 63
    s_nop 1
    v_subrev_f32 v144, s36, v144
    v_mul_f32 v144, 0x3fb8aa3b, v144
    v_exp_f32 v144, v144
    s_nop 0
    v_cvt_pk_bf16_f32 v146, v144, v144
    v_add_f32_dpp v144, v144, v144 row_ror:8 row_mask:0xf bank_mask:0xf
    s_nop 1
    v_add_f32_dpp v144, v144, v144 row_ror:4 row_mask:0xf bank_mask:0xf
    s_nop 1
    v_add_f32_dpp v144, v144, v144 row_ror:2 row_mask:0xf bank_mask:0xf
    s_nop 1
    v_add_f32_dpp v144, v144, v144 row_ror:1 row_mask:0xf bank_mask:0xf
    s_nop 1
    v_add_f32_dpp v144, v144, v144 row_bcast:15 row_mask:0xa bank_mask:0xf
    s_nop 1
    v_add_f32_dpp v144, v144, v144 row_bcast:31 row_mask:0xc bank_mask:0xf
    s_nop 0
    v_readlane_b32 s37, v144, 63
    v_mov_b32 v148, s36
    v_mul_f32 v148, 0x3fb8aa3b, v148
    v_mov_b32 v149, s37
    s_lshl_b32 s34, s30, 3
    v_mov_b32 v147, s34
    v_mov_b32 v150, 1
    v_mov_b32 v151, 0
    s_mov_b64 exec, 1
    ds_write_b64 v147, v[148:149] offset:512
    ds_add_u32 v151, v150 offset:4
    s_mov_b64 exec, -1
    v_and_b32_dpp v8, v146, v4 row_newbcast:0 row_mask:0xf bank_mask:0xf
    v_and_b32_dpp v9, v146, v5 row_newbcast:0 row_mask:0xf bank_mask:0xf
    v_and_b32_dpp v10, v146, v6 row_newbcast:0 row_mask:0xf bank_mask:0xf
    v_and_b32_dpp v11, v146, v7 row_newbcast:0 row_mask:0xf bank_mask:0xf
    v_and_b32_dpp v12, v146, v4 row_newbcast:1 row_mask:0xf bank_mask:0xf
    v_and_b32_dpp v13, v146, v5 row_newbcast:1 row_mask:0xf bank_mask:0xf
    v_and_b32_dpp v14, v146, v6 row_newbcast:1 row_mask:0xf bank_mask:0xf
    v_and_b32_dpp v15, v146, v7 row_newbcast:1 row_mask:0xf bank_mask:0xf
    v_and_b32_dpp v16, v146, v4 row_newbcast:2 row_mask:0xf bank_mask:0xf
    v_and_b32_dpp v17, v146, v5 row_newbcast:2 row_mask:0xf bank_mask:0xf
    v_and_b32_dpp v18, v146, v6 row_newbcast:2 row_mask:0xf bank_mask:0xf
    v_and_b32_dpp v19, v146, v7 row_newbcast:2 row_mask:0xf bank_mask:0xf
    v_and_b32_dpp v20, v146, v4 row_newbcast:3 row_mask:0xf bank_mask:0xf
    v_and_b32_dpp v21, v146, v5 row_newbcast:3 row_mask:0xf bank_mask:0xf
    v_and_b32_dpp v22, v146, v6 row_newbcast:3 row_mask:0xf bank_mask:0xf
    v_and_b32_dpp v23, v146, v7 row_newbcast:3 row_mask:0xf bank_mask:0xf
    v_and_b32_dpp v24, v146, v4 row_newbcast:4 row_mask:0xf bank_mask:0xf
    v_and_b32_dpp v25, v146, v5 row_newbcast:4 row_mask:0xf bank_mask:0xf
    v_and_b32_dpp v26, v146, v6 row_newbcast:4 row_mask:0xf bank_mask:0xf
    v_and_b32_dpp v27, v146, v7 row_newbcast:4 row_mask:0xf bank_mask:0xf
    v_and_b32_dpp v28, v146, v4 row_newbcast:5 row_mask:0xf bank_mask:0xf
    v_and_b32_dpp v29, v146, v5 row_newbcast:5 row_mask:0xf bank_mask:0xf
    v_and_b32_dpp v30, v146, v6 row_newbcast:5 row_mask:0xf bank_mask:0xf
    v_and_b32_dpp v31, v146, v7 row_newbcast:5 row_mask:0xf bank_mask:0xf
    v_and_b32_dpp v32, v146, v4 row_newbcast:6 row_mask:0xf bank_mask:0xf
    v_and_b32_dpp v33, v146, v5 row_newbcast:6 row_mask:0xf bank_mask:0xf
    v_and_b32_dpp v34, v146, v6 row_newbcast:6 row_mask:0xf bank_mask:0xf
    v_and_b32_dpp v35, v146, v7 row_newbcast:6 row_mask:0xf bank_mask:0xf
    v_and_b32_dpp v36, v146, v4 row_newbcast:7 row_mask:0xf bank_mask:0xf
    v_and_b32_dpp v37, v146, v5 row_newbcast:7 row_mask:0xf bank_mask:0xf
    v_and_b32_dpp v38, v146, v6 row_newbcast:7 row_mask:0xf bank_mask:0xf
    v_and_b32_dpp v39, v146, v7 row_newbcast:7 row_mask:0xf bank_mask:0xf
    v_and_b32_dpp v40, v146, v4 row_newbcast:8 row_mask:0xf bank_mask:0xf
    v_and_b32_dpp v41, v146, v5 row_newbcast:8 row_mask:0xf bank_mask:0xf
    v_and_b32_dpp v42, v146, v6 row_newbcast:8 row_mask:0xf bank_mask:0xf
    v_and_b32_dpp v43, v146, v7 row_newbcast:8 row_mask:0xf bank_mask:0xf
    v_and_b32_dpp v44, v146, v4 row_newbcast:9 row_mask:0xf bank_mask:0xf
    v_and_b32_dpp v45, v146, v5 row_newbcast:9 row_mask:0xf bank_mask:0xf
    v_and_b32_dpp v46, v146, v6 row_newbcast:9 row_mask:0xf bank_mask:0xf
    v_and_b32_dpp v47, v146, v7 row_newbcast:9 row_mask:0xf bank_mask:0xf
    v_and_b32_dpp v48, v146, v4 row_newbcast:10 row_mask:0xf bank_mask:0xf
    v_and_b32_dpp v49, v146, v5 row_newbcast:10 row_mask:0xf bank_mask:0xf
    v_and_b32_dpp v50, v146, v6 row_newbcast:10 row_mask:0xf bank_mask:0xf
    v_and_b32_dpp v51, v146, v7 row_newbcast:10 row_mask:0xf bank_mask:0xf
    v_and_b32_dpp v52, v146, v4 row_newbcast:11 row_mask:0xf bank_mask:0xf
    v_and_b32_dpp v53, v146, v5 row_newbcast:11 row_mask:0xf bank_mask:0xf
    v_and_b32_dpp v54, v146, v6 row_newbcast:11 row_mask:0xf bank_mask:0xf
    v_and_b32_dpp v55, v146, v7 row_newbcast:11 row_mask:0xf bank_mask:0xf
    v_and_b32_dpp v56, v146, v4 row_newbcast:12 row_mask:0xf bank_mask:0xf
    v_and_b32_dpp v57, v146, v5 row_newbcast:12 row_mask:0xf bank_mask:0xf
    v_and_b32_dpp v58, v146, v6 row_newbcast:12 row_mask:0xf bank_mask:0xf
    v_and_b32_dpp v59, v146, v7 row_newbcast:12 row_mask:0xf bank_mask:0xf
    v_and_b32_dpp v60, v146, v4 row_newbcast:13 row_mask:0xf bank_mask:0xf
    v_and_b32_dpp v61, v146, v5 row_newbcast:13 row_mask:0xf bank_mask:0xf
    v_and_b32_dpp v62, v146, v6 row_newbcast:13 row_mask:0xf bank_mask:0xf
    v_and_b32_dpp v63, v146, v7 row_newbcast:13 row_mask:0xf bank_mask:0xf
    v_and_b32_dpp v64, v146, v4 row_newbcast:14 row_mask:0xf bank_mask:0xf
    v_and_b32_dpp v65, v146, v5 row_newbcast:14 row_mask:0xf bank_mask:0xf
    v_and_b32_dpp v66, v146, v6 row_newbcast:14 row_mask:0xf bank_mask:0xf
    v_and_b32_dpp v67, v146, v7 row_newbcast:14 row_mask:0xf bank_mask:0xf
    v_and_b32_dpp v68, v146, v4 row_newbcast:15 row_mask:0xf bank_mask:0xf
    v_and_b32_dpp v69, v146, v5 row_newbcast:15 row_mask:0xf bank_mask:0xf
    v_and_b32_dpp v70, v146, v6 row_newbcast:15 row_mask:0xf bank_mask:0xf
    v_and_b32_dpp v71, v146, v7 row_newbcast:15 row_mask:0xf bank_mask:0xf
    v_lshlrev_b32 v147, 5, v1
    v_lshl_add_u32 v147, v2, 4, v147
    s_lshl_b32 s34, s30, 9
    v_add_u32 v147, s34, v147
    s_waitcnt vmcnt(15)
    v_mfma_f32_16x16x32_bf16 v[152:155], v[8:11], v[72:75], 0
    s_waitcnt vmcnt(14)
    v_mfma_f32_16x16x32_bf16 v[152:155], v[12:15], v[76:79], v[152:155]
    s_waitcnt vmcnt(13)
    v_mfma_f32_16x16x32_bf16 v[152:155], v[16:19], v[80:83], v[152:155]
    s_waitcnt vmcnt(12)
    v_mfma_f32_16x16x32_bf16 v[152:155], v[20:23], v[84:87], v[152:155]
    s_waitcnt vmcnt(11)
    v_mfma_f32_16x16x32_bf16 v[152:155], v[24:27], v[88:91], v[152:155]
    s_waitcnt vmcnt(10)
    v_mfma_f32_16x16x32_bf16 v[152:155], v[28:31], v[92:95], v[152:155]
    s_waitcnt vmcnt(9)
    v_mfma_f32_16x16x32_bf16 v[152:155], v[32:35], v[96:99], v[152:155]
    s_waitcnt vmcnt(8)
    v_mfma_f32_16x16x32_bf16 v[152:155], v[36:39], v[100:103], v[152:155]
    s_waitcnt vmcnt(7)
    v_mfma_f32_16x16x32_bf16 v[152:155], v[40:43], v[104:107], v[152:155]
    s_waitcnt vmcnt(6)
    v_mfma_f32_16x16x32_bf16 v[152:155], v[44:47], v[108:111], v[152:155]
    s_waitcnt vmcnt(5)
    v_mfma_f32_16x16x32_bf16 v[152:155], v[48:51], v[112:115], v[152:155]
    s_waitcnt vmcnt(4)
    v_mfma_f32_16x16x32_bf16 v[152:155], v[52:55], v[116:119], v[152:155]
    s_waitcnt vmcnt(3)
    v_mfma_f32_16x16x32_bf16 v[152:155], v[56:59], v[120:123], v[152:155]
    s_waitcnt vmcnt(2)
    v_mfma_f32_16x16x32_bf16 v[152:155], v[60:63], v[124:127], v[152:155]
    s_waitcnt vmcnt(1)
    v_mfma_f32_16x16x32_bf16 v[152:155], v[64:67], v[128:131], v[152:155]
    s_waitcnt vmcnt(0)
    v_mfma_f32_16x16x32_bf16 v[152:155], v[68:71], v[132:135], v[152:155]
    s_mov_b64 exec, 0xffffffff
    s_nop 6
    ds_write_b128 v147, v[152:155] offset:1024
    s_mov_b64 exec, 1
    ds_add_u32 v151, v150 offset:8
    s_endpgm
L_helpers:
    s_cmp_eq_u32 s30, -1
    s_cbranch_scc1 L_mt
    v_lshlrev_b32 v3, 4, v0
    s_lshr_b32 s36, s32, 1
    s_lshl_b32 s36, s36, 7
    v_lshrrev_b32 v4, 3, v1
    v_lshl_add_u32 v4, v2, 1, v4
    v_add_u32 v8, s36, v4
    s_and_b32 s34, s32, 1
    s_lshl1_add_u32 s34, s31, s34
    s_lshl_b32 s34, s34, 7
    v_and_b32 v5, 7, v1
    v_lshlrev_b32 v4, 13, v8
    v_lshl_add_u32 v4, v5, 4, v4
    v_add_u32 v4, s34, v4
    s_mov_b32 s35, 0x10000
    s_waitcnt lgkmcnt(0)
    global_load_dwordx4 v[12:15], v3, s[4:5]
    global_load_dwordx4 v[16:19], v4, s[10:11] nt
    v_add_u32 v4, s35, v4
    global_load_dwordx4 v[20:23], v4, s[10:11] nt
    v_add_u32 v4, s35, v4
    global_load_dwordx4 v[24:27], v4, s[10:11] nt
    v_add_u32 v4, s35, v4
    global_load_dwordx4 v[28:31], v4, s[10:11] nt
    v_add_u32 v4, s35, v4
    global_load_dwordx4 v[32:35], v4, s[10:11] nt
    v_add_u32 v4, s35, v4
    global_load_dwordx4 v[36:39], v4, s[10:11] nt
    v_add_u32 v4, s35, v4
    global_load_dwordx4 v[40:43], v4, s[10:11] nt
    v_add_u32 v4, s35, v4
    global_load_dwordx4 v[44:47], v4, s[10:11] nt
    v_add_u32 v4, s35, v4
    global_load_dwordx4 v[48:51], v4, s[10:11] nt
    v_add_u32 v4, s35, v4
    global_load_dwordx4 v[52:55], v4, s[10:11] nt
    v_add_u32 v4, s35, v4
    global_load_dwordx4 v[56:59], v4, s[10:11] nt
    v_add_u32 v4, s35, v4
    global_load_dwordx4 v[60:63], v4, s[10:11] nt
    v_add_u32 v4, s35, v4
    global_load_dwordx4 v[64:67], v4, s[10:11] nt
    v_add_u32 v4, s35, v4
    global_load_dwordx4 v[68:71], v4, s[10:11] nt
    v_add_u32 v4, s35, v4
    global_load_dwordx4 v[72:75], v4, s[10:11] nt
    v_add_u32 v4, s35, v4
    global_load_dwordx4 v[76:79], v4, s[10:11] nt
    s_load_dwordx8 s[20:27], s[0:1], 64
    s_load_dwordx2 s[28:29], s[0:1], 96
    s_waitcnt lgkmcnt(0)
    s_load_dword s33, s[28:29], 0
    v_and_b32 v3, 1, v1
    v_lshlrev_b32 v3, 4, v3
    s_mov_b32 s34, 0xffff
    v_lshlrev_b32 v3, v3, s34
    s_mov_b32 s34, 0x3030303
    s_mov_b32 s35, 0x3030303
    v_cndmask_b32 v4, 0, v3, s[34:35]
    s_mov_b32 s34, 0xc0c0c0c
    s_mov_b32 s35, 0xc0c0c0c
    v_cndmask_b32 v5, 0, v3, s[34:35]
    s_mov_b32 s34, 0x30303030
    s_mov_b32 s35, 0x30303030
    v_cndmask_b32 v6, 0, v3, s[34:35]
    s_mov_b32 s34, 0xc0c0c0c0
    s_mov_b32 s35, 0xc0c0c0c0
    v_cndmask_b32 v7, 0, v3, s[34:35]
    s_getreg_b32 s48, hwreg(HW_REG_XCC_ID)
    s_lshl_b32 s34, s31, 11
    s_add_u32 s34, s34, 1114112
    v_lshlrev_b32 v10, 4, v0
    v_add_u32 v10, s34, v10
    s_lshl_b32 s35, s32, 8
    s_add_u32 s34, s34, s35
    v_lshlrev_b32 v11, 5, v1
    v_lshl_add_u32 v11, v2, 4, v11
    v_add_u32 v11, s34, v11
    s_waitcnt vmcnt(16)
    v_lshlrev_b32 v96, 16, v12
    v_and_b32 v97, 0xffff0000, v12
    v_lshlrev_b32 v98, 16, v13
    v_and_b32 v99, 0xffff0000, v13
    v_lshlrev_b32 v100, 16, v14
    v_and_b32 v101, 0xffff0000, v14
    v_lshlrev_b32 v102, 16, v15
    v_and_b32 v103, 0xffff0000, v15
    v_add_f32 v104, v96, v97
    v_add_f32 v104, v104, v98
    v_add_f32 v104, v104, v99
    v_add_f32 v104, v104, v100
    v_add_f32 v104, v104, v101
    v_add_f32 v104, v104, v102
    v_add_f32 v104, v104, v103
    v_mul_f32 v104, 0x3b000000, v104
    s_nop 1
    v_add_f32_dpp v104, v104, v104 row_ror:8 row_mask:0xf bank_mask:0xf
    s_nop 1
    v_add_f32_dpp v104, v104, v104 row_ror:4 row_mask:0xf bank_mask:0xf
    s_nop 1
    v_add_f32_dpp v104, v104, v104 row_ror:2 row_mask:0xf bank_mask:0xf
    s_nop 1
    v_add_f32_dpp v104, v104, v104 row_ror:1 row_mask:0xf bank_mask:0xf
    s_nop 1
    v_add_f32_dpp v104, v104, v104 row_bcast:15 row_mask:0xa bank_mask:0xf
    s_nop 1
    v_add_f32_dpp v104, v104, v104 row_bcast:31 row_mask:0xc bank_mask:0xf
    s_nop 0
    v_readlane_b32 s36, v104, 63
    s_nop 1
    v_subrev_f32 v106, s36, v96
    v_subrev_f32 v107, s36, v97
    v_subrev_f32 v108, s36, v98
    v_subrev_f32 v109, s36, v99
    v_subrev_f32 v110, s36, v100
    v_subrev_f32 v111, s36, v101
    v_subrev_f32 v112, s36, v102
    v_subrev_f32 v113, s36, v103
    v_mul_f32 v104, v106, v106
    v_fmac_f32 v104, v107, v107
    v_fmac_f32 v104, v108, v108
    v_fmac_f32 v104, v109, v109
    v_fmac_f32 v104, v110, v110
    v_fmac_f32 v104, v111, v111
    v_fmac_f32 v104, v112, v112
    v_fmac_f32 v104, v113, v113
    v_mul_f32 v104, 0x3b000000, v104
    s_nop 1
    v_add_f32_dpp v104, v104, v104 row_ror:8 row_mask:0xf bank_mask:0xf
    s_nop 1
    v_add_f32_dpp v104, v104, v104 row_ror:4 row_mask:0xf bank_mask:0xf
    s_nop 1
    v_add_f32_dpp v104, v104, v104 row_ror:2 row_mask:0xf bank_mask:0xf
    s_nop 1
    v_add_f32_dpp v104, v104, v104 row_ror:1 row_mask:0xf bank_mask:0xf
    s_nop 1
    v_add_f32_dpp v104, v104, v104 row_bcast:15 row_mask:0xa bank_mask:0xf
    s_nop 1
    v_add_f32_dpp v104, v104, v104 row_bcast:31 row_mask:0xc bank_mask:0xf
    s_nop 0
    v_readlane_b32 s37, v104, 63
    s_nop 1
    v_mov_b32 v104, s37
    v_mov_b32 v105, s36
    v_cvt_pk_bf16_f32 v104, v104, v104
    v_lshlrev_b32 v104, 16, v104
    v_cvt_pk_bf16_f32 v105, v105, v105
    v_lshlrev_b32 v105, 16, v105
    v_add_f32 v104, 0x3727c5ac, v104
    v_cvt_pk_bf16_f32 v104, v104, v104
    v_lshlrev_b32 v104, 16, v104
    v_sqrt_f32 v104, v104
    s_nop 0
    v_cvt_pk_bf16_f32 v104, v104, v104
    v_lshlrev_b32 v104, 16, v104
    v_rcp_f32 v104, v104
    v_sub_f32 v106, v96, v105
    v_sub_f32 v107, v97, v105
    v_sub_f32 v108, v98, v105
    v_sub_f32 v109, v99, v105
    v_sub_f32 v110, v100, v105
    v_sub_f32 v111, v101, v105
    v_sub_f32 v112, v102, v105
    v_sub_f32 v113, v103, v105
    v_cvt_pk_bf16_f32 v12, v106, v107
    v_cvt_pk_bf16_f32 v13, v108, v109
    v_cvt_pk_bf16_f32 v14, v110, v111
    v_cvt_pk_bf16_f32 v15, v112, v113
    v_lshlrev_b32 v106, 16, v12
    v_and_b32 v107, 0xffff0000, v12
    v_lshlrev_b32 v108, 16, v13
    v_and_b32 v109, 0xffff0000, v13
    v_lshlrev_b32 v110, 16, v14
    v_and_b32 v111, 0xffff0000, v14
    v_lshlrev_b32 v112, 16, v15
    v_and_b32 v113, 0xffff0000, v15
    v_mul_f32 v106, v106, v104
    v_mul_f32 v107, v107, v104
    v_mul_f32 v108, v108, v104
    v_mul_f32 v109, v109, v104
    v_mul_f32 v110, v110, v104
    v_mul_f32 v111, v111, v104
    v_mul_f32 v112, v112, v104
    v_mul_f32 v113, v113, v104
    v_cvt_pk_bf16_f32 v12, v106, v107
    v_cvt_pk_bf16_f32 v13, v108, v109
    v_cvt_pk_bf16_f32 v14, v110, v111
    v_cvt_pk_bf16_f32 v15, v112, v113
    s_mov_b32 s34, 0x01000100
    s_mov_b32 s35, 0x03020302
    v_perm_b32 v96, v12, v12, s34
    v_perm_b32 v97, v12, v12, s35
    v_perm_b32 v98, v13, v13, s34
    v_perm_b32 v99, v13, v13, s35
    v_perm_b32 v100, v14, v14, s34
    v_perm_b32 v101, v14, v14, s35
    v_perm_b32 v102, v15, v15, s34
    v_perm_b32 v103, v15, v15, s35
    v_lshlrev_b32 v3, 5, v0
    ds_write_b128 v3, v[96:99] offset:5120
    ds_write_b128 v3, v[100:103] offset:5136
    v_lshlrev_b32 v3, 2, v8
    s_waitcnt lgkmcnt(0)
    s_add_u32 s33, s33, 0x9e3779b9
    v_mov_b32 v9, s33
    ds_read_b32 v104, v3 offset:5120
    ds_read_b32 v105, v3 offset:5152
    ds_read_b32 v106, v3 offset:5184
    ds_read_b32 v107, v3 offset:5216
    ds_read_b32 v108, v3 offset:5248
    ds_read_b32 v109, v3 offset:5280
    ds_read_b32 v110, v3 offset:5312
    ds_read_b32 v111, v3 offset:5344
    ds_read_b32 v112, v3 offset:5376
    ds_read_b32 v113, v3 offset:5408
    ds_read_b32 v114, v3 offset:5440
    ds_read_b32 v115, v3 offset:5472
    ds_read_b32 v116, v3 offset:5504
    ds_read_b32 v117, v3 offset:5536
    ds_read_b32 v118, v3 offset:5568
    ds_read_b32 v119, v3 offset:5600
    s_lshr_b32 s49, s48, 1
    s_lshr_b32 s50, s48, 2
    s_and_b32 s48, s48, 1
    s_and_b32 s49, s49, 1
    s_and_b32 s50, s50, 1
    s_lshr_b32 s43, s33, 4
    s_xor_b32 s43, s43, s48
    s_lshr_b32 s44, s33, 8
    s_xor_b32 s44, s44, s49
    s_lshr_b32 s45, s33, 12
    s_xor_b32 s45, s45, s50
    s_waitcnt lgkmcnt(0)
    v_and_b32 v80, v104, v4
    v_and_b32 v81, v104, v5
    v_and_b32 v82, v104, v6
    v_and_b32 v83, v104, v7
    s_waitcnt vmcnt(15)
    s_nop 0
    v_mfma_f32_16x16x32_bf16 v[96:99], v[80:83], v[16:19], 0
    v_and_b32 v84, v105, v4
    v_and_b32 v85, v105, v5
    v_and_b32 v86, v105, v6
    v_and_b32 v87, v105, v7
    s_waitcnt vmcnt(14)
    s_nop 0
    v_mfma_f32_16x16x32_bf16 v[96:99], v[84:87], v[20:23], v[96:99]
    v_and_b32 v88, v106, v4
    v_and_b32 v89, v106, v5
    v_and_b32 v90, v106, v6
    v_and_b32 v91, v106, v7
    s_waitcnt vmcnt(13)
    s_nop 0
    v_mfma_f32_16x16x32_bf16 v[96:99], v[88:91], v[24:27], v[96:99]
    v_and_b32 v92, v107, v4
    v_and_b32 v93, v107, v5
    v_and_b32 v94, v107, v6
    v_and_b32 v95, v107, v7
    s_waitcnt vmcnt(12)
    s_nop 0
    v_mfma_f32_16x16x32_bf16 v[96:99], v[92:95], v[28:31], v[96:99]
    v_and_b32 v80, v108, v4
    v_and_b32 v81, v108, v5
    v_and_b32 v82, v108, v6
    v_and_b32 v83, v108, v7
    s_waitcnt vmcnt(11)
    s_nop 0
    v_mfma_f32_16x16x32_bf16 v[96:99], v[80:83], v[32:35], v[96:99]
    v_and_b32 v84, v109, v4
    v_and_b32 v85, v109, v5
    v_and_b32 v86, v109, v6
    v_and_b32 v87, v109, v7
    s_waitcnt vmcnt(10)
    s_nop 0
    v_mfma_f32_16x16x32_bf16 v[96:99], v[84:87], v[36:39], v[96:99]
    v_and_b32 v88, v110, v4
    v_and_b32 v89, v110, v5
    v_and_b32 v90, v110, v6
    v_and_b32 v91, v110, v7
    s_waitcnt vmcnt(9)
    s_nop 0
    v_mfma_f32_16x16x32_bf16 v[96:99], v[88:91], v[40:43], v[96:99]
    v_and_b32 v92, v111, v4
    v_and_b32 v93, v111, v5
    v_and_b32 v94, v111, v6
    v_and_b32 v95, v111, v7
    s_waitcnt vmcnt(8)
    s_nop 0
    v_mfma_f32_16x16x32_bf16 v[96:99], v[92:95], v[44:47], v[96:99]
    v_and_b32 v80, v112, v4
    v_and_b32 v81, v112, v5
    v_and_b32 v82, v112, v6
    v_and_b32 v83, v112, v7
    s_waitcnt vmcnt(7)
    s_nop 0
    v_mfma_f32_16x16x32_bf16 v[96:99], v[80:83], v[48:51], v[96:99]
    v_and_b32 v84, v113, v4
    v_and_b32 v85, v113, v5
    v_and_b32 v86, v113, v6
    v_and_b32 v87, v113, v7
    s_waitcnt vmcnt(6)
    s_nop 0
    v_mfma_f32_16x16x32_bf16 v[96:99], v[84:87], v[52:55], v[96:99]
    v_and_b32 v88, v114, v4
    v_and_b32 v89, v114, v5
    v_and_b32 v90, v114, v6
    v_and_b32 v91, v114, v7
    s_waitcnt vmcnt(5)
    s_nop 0
    v_mfma_f32_16x16x32_bf16 v[96:99], v[88:91], v[56:59], v[96:99]
    v_and_b32 v92, v115, v4
    v_and_b32 v93, v115, v5
    v_and_b32 v94, v115, v6
    v_and_b32 v95, v115, v7
    s_waitcnt vmcnt(4)
    s_nop 0
    v_mfma_f32_16x16x32_bf16 v[96:99], v[92:95], v[60:63], v[96:99]
    v_and_b32 v80, v116, v4
    v_and_b32 v81, v116, v5
    v_and_b32 v82, v116, v6
    v_and_b32 v83, v116, v7
    s_waitcnt vmcnt(3)
    s_nop 0
    v_mfma_f32_16x16x32_bf16 v[96:99], v[80:83], v[64:67], v[96:99]
    v_and_b32 v84, v117, v4
    v_and_b32 v85, v117, v5
    v_and_b32 v86, v117, v6
    v_and_b32 v87, v117, v7
    s_waitcnt vmcnt(2)
    s_nop 0
    v_mfma_f32_16x16x32_bf16 v[96:99], v[84:87], v[68:71], v[96:99]
    v_and_b32 v88, v118, v4
    v_and_b32 v89, v118, v5
    v_and_b32 v90, v118, v6
    v_and_b32 v91, v118, v7
    s_waitcnt vmcnt(1)
    s_nop 0
    v_mfma_f32_16x16x32_bf16 v[96:99], v[88:91], v[72:75], v[96:99]
    v_and_b32 v92, v119, v4
    v_and_b32 v93, v119, v5
    v_and_b32 v94, v119, v6
    v_and_b32 v95, v119, v7
    s_waitcnt vmcnt(0)
    s_nop 0
    v_mfma_f32_16x16x32_bf16 v[96:99], v[92:95], v[76:79], v[96:99]
    s_nop 7
    v_mov_b32_dpp v100, v96 row_ror:8 row_mask:0xf bank_mask:0xf
    v_mov_b32_dpp v101, v97 row_ror:8 row_mask:0xf bank_mask:0xf
    v_mov_b32_dpp v102, v98 row_ror:8 row_mask:0xf bank_mask:0xf
    v_mov_b32_dpp v103, v99 row_ror:8 row_mask:0xf bank_mask:0xf
    v_permlane32_swap_b32 v100, v104
    v_permlane32_swap_b32 v101, v105
    v_permlane32_swap_b32 v102, v106
    v_permlane32_swap_b32 v103, v107
    v_add_f32 v96, v96, v104
    v_add_f32 v97, v97, v105
    v_add_f32 v98, v98, v106
    v_add_f32 v99, v99, v107
    v_add_u32 v96, 8, v96
    v_add_u32 v97, 8, v97
    v_add_u32 v98, 8, v98
    v_add_u32 v99, 8, v99
    v_bfi_b32 v96, 15, s33, v96
    v_bfi_b32 v97, 15, s43, v97
    v_bfi_b32 v98, 15, s44, v98
    v_bfi_b32 v99, 15, s45, v99
    s_mov_b64 exec, 0x00ff00ff
    global_store_dwordx4 v11, v[96:99], s[28:29]
    s_mov_b64 exec, -1
    s_waitcnt vmcnt(0)
    s_mov_b32 s40, 0
    s_mov_b64 s[76:77], -1
    s_mov_b64 s[78:79], -1
L_pq:
    s_mov_b64 exec, s[76:77]
    global_load_dwordx4 v[16:19], v10, s[28:29] offset:0 sc1
    s_mov_b64 exec, s[78:79]
    global_load_dwordx4 v[20:23], v10, s[28:29] offset:1024 sc1
    s_mov_b64 exec, -1
L_pq_c:
L_pq_s:
    s_add_u32 s40, s40, 1
    s_waitcnt vmcnt(1)
    v_xor_b32 v40, s33, v16
    v_xor_b32 v41, s43, v17
    v_or_b32 v40, v40, v41
    v_xor_b32 v41, s44, v18
    v_or_b32 v40, v40, v41
    v_xor_b32 v41, s45, v19
    v_or_b32 v40, v40, v41
    v_and_b32 v40, 15, v40
    v_cmp_ne_u32 vcc, 0, v40
    s_nop 0
    s_cmp_lg_u64 vcc, 0
    s_cselect_b64 s[76:77], s[76:77], 0
    s_waitcnt vmcnt(0)
    v_xor_b32 v40, s33, v20
    v_xor_b32 v41, s43, v21
    v_or_b32 v40, v40, v41
    v_xor_b32 v41, s44, v22
    v_or_b32 v40, v40, v41
    v_xor_b32 v41, s45, v23
    v_or_b32 v40, v40, v41
    v_and_b32 v40, 15, v40
    v_cmp_ne_u32 vcc, 0, v40
    s_nop 0
    s_cmp_lg_u64 vcc, 0
    s_cselect_b64 s[78:79], s[78:79], 0
    s_or_b64 s[34:35], s[76:77], s[78:79]
    s_cbranch_scc0 L_pq_x
    s_add_u32 s34, s40, 1
    s_and_b32 s35, s34, 6
    s_cbranch_scc1 L_qf
    v_xor_b32 v10, 1048576, v10
    s_xor_b32 s43, s43, s48
    s_xor_b32 s44, s44, s49
    s_xor_b32 s45, s45, s50
    s_bitcmp1_b32 s34, 0
    s_cbranch_scc1 L_qf
    v_bfi_b32 v97, 15, s43, v97
    v_bfi_b32 v98, 15, s44, v98
    v_bfi_b32 v99, 15, s45, v99
    v_xor_b32 v3, 1048576, v11
    s_mov_b64 exec, 0x00ff00ff
    global_store_dwordx4 v3, v[96:99], s[28:29] sc1
    s_mov_b64 exec, -1
L_qf:
    s_cmp_lt_u32 s40, 1048576
    s_cbranch_scc1 L_pq
L_pq_x:
    v_and_b32 v16, -16, v16
    v_and_b32 v17, -16, v17
    v_and_b32 v18, -16, v18
    v_and_b32 v19, -16, v19
    v_and_b32 v20, -16, v20
    v_and_b32 v21, -16, v21
    v_and_b32 v22, -16, v22
    v_and_b32 v23, -16, v23
    v_add_f32 v16, v16, v20
    v_add_f32 v17, v17, v21
    v_add_f32 v18, v18, v22
    v_add_f32 v19, v19, v23
    s_nop 0
    v_permlane32_swap_b32 v16, v18
    v_permlane32_swap_b32 v17, v19
    v_add_f32 v16, v16, v18
    v_add_f32 v17, v17, v19
    v_cvt_pk_bf16_f32 v16, v16, v17
    v_and_b32 v3, 31, v0
    v_lshlrev_b32 v3, 3, v3
    v_lshrrev_b32 v8, 5, v0
    v_lshl_add_u32 v3, v8, 2, v3
    ds_write_b32 v3, v16 offset:256
    v_mov_b32 v4, 0
    v_mov_b32 v5, 1
    s_waitcnt lgkmcnt(0)
    s_mov_b64 exec, 1
    ds_write_b32 v4, v5 offset:0
    s_mov_b64 exec, -1
    s_mov_b32 s41, s2
    s_cmp_ge_u32 s2, 64
    s_cbranch_scc1 L_end
    v_and_b32 v3, 1, v0
    v_lshl_add_u32 v3, v3, 2, v2
    v_lshlrev_b32 v3, 1, v3
    s_lshl_b32 s34, s41, 4
    v_add_u32 v12, s34, v3
    global_load_ushort v10, v12, s[4:5]
    global_load_ushort v11, v12, s[22:23] nt
    s_mov_b32 s56, 0x0c0c0400
    s_mov_b32 s57, 0x04000c0c
    v_lshlrev_b32 v3, 4, v0
    s_lshl_b32 s34, s41, 11
    s_add_u32 s35, s34, 524288
    v_add_u32 v13, s35, v3
    s_cmp_eq_u32 s41, 0
    s_cselect_b32 s94, 1, 0
    s_mov_b32 s95, 0
    s_waitcnt vmcnt(0)
    v_lshlrev_b32 v10, 16, v10
    v_lshlrev_b32 v11, 16, v11
    v_add_f32 v10, v10, v11
    s_mov_b32 s40, 0
L_wf:
    s_sleep 2
    v_mov_b32 v3, 0
    ds_read_b32 v3, v3 offset:8
    s_add_u32 s40, s40, 1
    s_waitcnt lgkmcnt(0)
    v_readfirstlane_b32 s36, v3
    s_cmp_ge_u32 s40, 16777216
    s_cbranch_scc1 L_wf_x
    s_cmp_lt_u32 s36, 8
    s_cbranch_scc1 L_wf
L_wf_x:
    s_mov_b32 s40, 0
L_wf2:
    ds_read_b32 v3, v4 offset:8
    s_add_u32 s40, s40, 1
    s_waitcnt lgkmcnt(0)
    v_readfirstlane_b32 s36, v3
    s_cmp_ge_u32 s40, 16777216
    s_cbranch_scc1 L_wf2_x
    s_cmp_lt_u32 s36, 9
    s_cbranch_scc1 L_wf2
L_wf2_x:
    s_mov_b32 s40, 0
    s_mov_b64 s[76:77], -1
    s_mov_b64 s[78:79], -1
L_pa:
    s_mov_b64 exec, s[76:77]
    global_load_dwordx4 v[16:19], v13, s[28:29] offset:0 sc1
    s_mov_b64 exec, s[78:79]
    global_load_dwordx4 v[20:23], v13, s[28:29] offset:1024 sc1
    s_mov_b64 exec, -1
L_pa_c:
L_pa_s:
    s_add_u32 s40, s40, 1
    s_waitcnt vmcnt(1)
    v_perm_b32 v40, v17, v16, s56
    v_perm_b32 v41, v19, v18, s57
    v_or_b32 v40, v40, v41
    v_cmp_ne_u32 s[76:77], s33, v40
    s_waitcnt vmcnt(0)
    v_perm_b32 v40, v21, v20, s56
    v_perm_b32 v41, v23, v22, s57
    v_or_b32 v40, v40, v41
    v_cmp_ne_u32 s[78:79], s33, v40
    s_nop 0
    s_or_b64 s[34:35], s[76:77], s[78:79]
    s_cbranch_scc0 L_pa_x
    s_cmp_lt_u32 s40, 1048576
    s_cbranch_scc1 L_pa
L_pa_x:
    v_and_b32 v16, 0xffffff00, v16
    v_and_b32 v17, 0xffffff00, v17
    v_and_b32 v18, 0xffffff00, v18
    v_and_b32 v19, 0xffffff00, v19
    v_and_b32 v20, 0xffffff00, v20
    v_and_b32 v21, 0xffffff00, v21
    v_and_b32 v22, 0xffffff00, v22
    v_and_b32 v23, 0xffffff00, v23
    v_add_f32 v16, v16, v20
    v_add_f32 v17, v17, v21
    v_add_f32 v18, v18, v22
    v_add_f32 v19, v19, v23
    s_nop 0
    v_permlane32_swap_b32 v16, v18
    v_permlane32_swap_b32 v17, v19
    v_add_f32 v16, v16, v18
    v_add_f32 v17, v17, v19
    s_nop 1
    v_permlane16_swap_b32 v16, v17
    v_add_f32 v16, v16, v17
    s_nop 1
    v_add_f32_dpp v16, v16, v16 quad_perm:[2,3,0,1] row_mask:0xf bank_mask:0xf
    s_nop 1
    v_add_f32_dpp v16, v16, v16 row_ror:4 row_mask:0xf bank_mask:0xf
    s_nop 1
    v_add_f32_dpp v16, v16, v16 row_ror:8 row_mask:0xf bank_mask:0xf
    s_mov_b32 exec_lo, 0x00030003
    s_mov_b32 exec_hi, 0x00030003
    v_add_f32 v16, v10, v16
    v_cvt_pk_bf16_f32 v16, v16, v16
    global_store_short v12, v16, s[24:25]
    s_mov_b64 exec, s[94:95]
    global_store_dword v4, v9, s[28:29] offset:0
    s_endpgm
L_mt:
    s_add_u32 s46, s46, 2
    s_and_b32 s46, s46, 3
    s_lshl_b32 s34, s47, 2
    s_lshr_b32 s35, 0x42fc9630, s34
    s_and_b32 s35, s35, 15
    s_bitcmp1_b32 0xc0, s47
    s_cselect_b32 s34, 16, 0
    s_add_u32 s35, s35, s34
    s_bitcmp1_b32 0x3f, s47
    s_cselect_b32 s34, 3, 2
    s_cmp_ge_u32 s46, s34
    s_cselect_b32 s35, 32, s35
    s_add_u32 s46, s46, s35
    s_mov_b32 s47, s32
    s_cmp_gt_u32 s46, 21
    s_cbranch_scc1 L_mt_no1
    v_lshlrev_b32 v3, 4, v0
    s_cmp_eq_u32 s46, 21
    s_cselect_b32 s35, 3, 7
    v_lshrrev_b32 v4, 3, v1
    v_lshl_add_u32 v4, v2, 1, v4
    s_lshl_b32 s34, s47, 6
    v_add_u32 v10, s34, v4
    v_mul_u32_u24 v4, 2752, v10
    v_and_b32 v5, s35, v1
    v_lshl_add_u32 v4, v5, 4, v4
    s_lshl_b32 s34, s46, 7
    v_add_u32 v4, s34, v4
    s_movk_i32 s35, 22016
    s_waitcnt lgkmcnt(0)
    global_load_dwordx4 v[12:15], v3, s[4:5]
    global_load_dwordx4 v[16:19], v4, s[16:17] nt
    v_add_u32 v4, s35, v4
    global_load_dwordx4 v[20:23], v4, s[16:17] nt
    v_add_u32 v4, s35, v4
    global_load_dwordx4 v[24:27], v4, s[16:17] nt
    v_add_u32 v4, s35, v4
    global_load_dwordx4 v[28:31], v4, s[16:17] nt
    v_add_u32 v4, s35, v4
    global_load_dwordx4 v[32:35], v4, s[16:17] nt
    v_add_u32 v4, s35, v4
    global_load_dwordx4 v[36:39], v4, s[16:17] nt
    v_add_u32 v4, s35, v4
    global_load_dwordx4 v[40:43], v4, s[16:17] nt
    v_add_u32 v4, s35, v4
    global_load_dwordx4 v[44:47], v4, s[16:17] nt
L_mt_no1:
    s_waitcnt lgkmcnt(0)
    s_lshl_b32 s34, s31, 22
    s_lshl_b32 s35, s32, 12
    s_add_u32 s34, s34, s35
    s_add_u32 s34, s34, 0x300000
    v_mov_b32 v164, s34
    s_lshl_b32 s34, s31, 17
    s_lshl_b32 s35, s32, 14
    s_add_u32 s34, s34, s35
    v_mov_b32 v165, s34
    s_mov_b64 exec, 1
    global_load_dword v60, v164, s[8:9] nt
    global_load_dword v61, v165, s[12:13] nt
    s_mov_b64 exec, -1
    s_load_dwordx8 s[20:27], s[0:1], 64
    s_load_dwordx2 s[28:29], s[0:1], 96
    s_waitcnt lgkmcnt(0)
    s_load_dword s33, s[28:29], 0
    s_mov_b32 s52, 0x7060500
    s_mov_b32 s53, 0x7060501
    s_mov_b32 s54, 0x7060502
    s_mov_b32 s55, 0x7060503
    s_lshr_b32 s41, s32, 2
    s_lshl_b32 s34, s46, 1
    s_add_u32 s41, s41, s34
    s_and_b32 s39, s32, 3
    s_getreg_b32 s48, hwreg(HW_REG_XCC_ID)
    s_and_b32 s48, s48, 7
    s_mul_i32 s49, s48, 0x01010101
    v_and_b32 v3, 1, v1
    v_lshlrev_b32 v3, 4, v3
    s_mov_b32 s34, 0xffff
    v_lshlrev_b32 v3, v3, s34
    s_mov_b32 s34, 0x3030303
    s_mov_b32 s35, 0x3030303
    v_cndmask_b32 v4, 0, v3, s[34:35]
    s_mov_b32 s34, 0xc0c0c0c
    s_mov_b32 s35, 0xc0c0c0c
    v_cndmask_b32 v5, 0, v3, s[34:35]
    s_mov_b32 s34, 0x30303030
    s_mov_b32 s35, 0x30303030
    v_cndmask_b32 v6, 0, v3, s[34:35]
    s_mov_b32 s34, 0xc0c0c0c0
    s_mov_b32 s35, 0xc0c0c0c0
    v_cndmask_b32 v7, 0, v3, s[34:35]
    s_cmp_gt_u32 s46, 21
    s_cbranch_scc1 L_mt_no1b
    s_waitcnt vmcnt(10)
    v_lshlrev_b32 v96, 16, v12
    v_and_b32 v97, 0xffff0000, v12
    v_lshlrev_b32 v98, 16, v13
    v_and_b32 v99, 0xffff0000, v13
    v_lshlrev_b32 v100, 16, v14
    v_and_b32 v101, 0xffff0000, v14
    v_lshlrev_b32 v102, 16, v15
    v_and_b32 v103, 0xffff0000, v15
    v_add_f32 v104, v96, v97
    v_add_f32 v104, v104, v98
    v_add_f32 v104, v104, v99
    v_add_f32 v104, v104, v100
    v_add_f32 v104, v104, v101
    v_add_f32 v104, v104, v102
    v_add_f32 v104, v104, v103
    v_mul_f32 v104, 0x3b000000, v104
    s_nop 1
    v_add_f32_dpp v104, v104, v104 row_ror:8 row_mask:0xf bank_mask:0xf
    s_nop 1
    v_add_f32_dpp v104, v104, v104 row_ror:4 row_mask:0xf bank_mask:0xf
    s_nop 1
    v_add_f32_dpp v104, v104, v104 row_ror:2 row_mask:0xf bank_mask:0xf
    s_nop 1
    v_add_f32_dpp v104, v104, v104 row_ror:1 row_mask:0xf bank_mask:0xf
    s_nop 1
    v_add_f32_dpp v104, v104, v104 row_bcast:15 row_mask:0xa bank_mask:0xf
    s_nop 1
    v_add_f32_dpp v104, v104, v104 row_bcast:31 row_mask:0xc bank_mask:0xf
    s_nop 0
    v_readlane_b32 s36, v104, 63
    s_nop 1
    v_subrev_f32 v106, s36, v96
    v_subrev_f32 v107, s36, v97
    v_subrev_f32 v108, s36, v98
    v_subrev_f32 v109, s36, v99
    v_subrev_f32 v110, s36, v100
    v_subrev_f32 v111, s36, v101
    v_subrev_f32 v112, s36, v102
    v_subrev_f32 v113, s36, v103
    v_mul_f32 v104, v106, v106
    v_fmac_f32 v104, v107, v107
    v_fmac_f32 v104, v108, v108
    v_fmac_f32 v104, v109, v109
    v_fmac_f32 v104, v110, v110
    v_fmac_f32 v104, v111, v111
    v_fmac_f32 v104, v112, v112
    v_fmac_f32 v104, v113, v113
    v_mul_f32 v104, 0x3b000000, v104
    s_nop 1
    v_add_f32_dpp v104, v104, v104 row_ror:8 row_mask:0xf bank_mask:0xf
    s_nop 1
    v_add_f32_dpp v104, v104, v104 row_ror:4 row_mask:0xf bank_mask:0xf
    s_nop 1
    v_add_f32_dpp v104, v104, v104 row_ror:2 row_mask:0xf bank_mask:0xf
    s_nop 1
    v_add_f32_dpp v104, v104, v104 row_ror:1 row_mask:0xf bank_mask:0xf
    s_nop 1
    v_add_f32_dpp v104, v104, v104 row_bcast:15 row_mask:0xa bank_mask:0xf
    s_nop 1
    v_add_f32_dpp v104, v104, v104 row_bcast:31 row_mask:0xc bank_mask:0xf
    s_nop 0
    v_readlane_b32 s37, v104, 63
    s_nop 1
    v_mov_b32 v104, s37
    v_mov_b32 v105, s36
    v_cvt_pk_bf16_f32 v104, v104, v104
    v_lshlrev_b32 v104, 16, v104
    v_cvt_pk_bf16_f32 v105, v105, v105
    v_lshlrev_b32 v105, 16, v105
    v_add_f32 v104, 0x3727c5ac, v104
    v_cvt_pk_bf16_f32 v104, v104, v104
    v_lshlrev_b32 v104, 16, v104
    v_sqrt_f32 v104, v104
    s_nop 0
    v_cvt_pk_bf16_f32 v104, v104, v104
    v_lshlrev_b32 v104, 16, v104
    v_rcp_f32 v104, v104
    v_sub_f32 v106, v96, v105
    v_sub_f32 v107, v97, v105
    v_sub_f32 v108, v98, v105
    v_sub_f32 v109, v99, v105
    v_sub_f32 v110, v100, v105
    v_sub_f32 v111, v101, v105
    v_sub_f32 v112, v102, v105
    v_sub_f32 v113, v103, v105
    v_cvt_pk_bf16_f32 v12, v106, v107
    v_cvt_pk_bf16_f32 v13, v108, v109
    v_cvt_pk_bf16_f32 v14, v110, v111
    v_cvt_pk_bf16_f32 v15, v112, v113
    v_lshlrev_b32 v106, 16, v12
    v_and_b32 v107, 0xffff0000, v12
    v_lshlrev_b32 v108, 16, v13
    v_and_b32 v109, 0xffff0000, v13
    v_lshlrev_b32 v110, 16, v14
    v_and_b32 v111, 0xffff0000, v14
    v_lshlrev_b32 v112, 16, v15
    v_and_b32 v113, 0xffff0000, v15
    v_mul_f32 v106, v106, v104
    v_mul_f32 v107, v107, v104
    v_mul_f32 v108, v108, v104
    v_mul_f32 v109, v109, v104
    v_mul_f32 v110, v110, v104
    v_mul_f32 v111, v111, v104
    v_mul_f32 v112, v112, v104
    v_mul_f32 v113, v113, v104
    v_cvt_pk_bf16_f32 v12, v106, v107
    v_cvt_pk_bf16_f32 v13, v108, v109
    v_cvt_pk_bf16_f32 v14, v110, v111
    v_cvt_pk_bf16_f32 v15, v112, v113
    v_lshlrev_b32 v96, 16, v12
    v_and_b32 v97, 0xffff0000, v12
    v_lshlrev_b32 v98, 16, v13
    v_and_b32 v99, 0xffff0000, v13
    v_lshlrev_b32 v100, 16, v14
    v_and_b32 v101, 0xffff0000, v14
    v_lshlrev_b32 v102, 16, v15
    v_and_b32 v103, 0xffff0000, v15
    v_add_f32 v104, v96, v97
    v_add_f32 v104, v104, v98
    v_add_f32 v104, v104, v99
    v_add_f32 v104, v104, v100
    v_add_f32 v104, v104, v101
    v_add_f32 v104, v104, v102
    v_add_f32 v104, v104, v103
    v_mul_f32 v104, 0x3b000000, v104
    s_nop 1
    v_add_f32_dpp v104, v104, v104 row_ror:8 row_mask:0xf bank_mask:0xf
    s_nop 1
    v_add_f32_dpp v104, v104, v104 row_ror:4 row_mask:0xf bank_mask:0xf
    s_nop 1
    v_add_f32_dpp v104, v104, v104 row_ror:2 row_mask:0xf bank_mask:0xf
    s_nop 1
    v_add_f32_dpp v104, v104, v104 row_ror:1 row_mask:0xf bank_mask:0xf
    s_nop 1
    v_add_f32_dpp v104, v104, v104 row_bcast:15 row_mask:0xa bank_mask:0xf
    s_nop 1
    v_add_f32_dpp v104, v104, v104 row_bcast:31 row_mask:0xc bank_mask:0xf
    s_nop 0
    v_readlane_b32 s36, v104, 63
    s_nop 1
    v_subrev_f32 v106, s36, v96
    v_subrev_f32 v107, s36, v97
    v_subrev_f32 v108, s36, v98
    v_subrev_f32 v109, s36, v99
    v_subrev_f32 v110, s36, v100
    v_subrev_f32 v111, s36, v101
    v_subrev_f32 v112, s36, v102
    v_subrev_f32 v113, s36, v103
    v_mul_f32 v104, v106, v106
    v_fmac_f32 v104, v107, v107
    v_fmac_f32 v104, v108, v108
    v_fmac_f32 v104, v109, v109
    v_fmac_f32 v104, v110, v110
    v_fmac_f32 v104, v111, v111
    v_fmac_f32 v104, v112, v112
    v_fmac_f32 v104, v113, v113
    v_mul_f32 v104, 0x3b000000, v104
    s_nop 1
    v_add_f32_dpp v104, v104, v104 row_ror:8 row_mask:0xf bank_mask:0xf
    s_nop 1
    v_add_f32_dpp v104, v104, v104 row_ror:4 row_mask:0xf bank_mask:0xf
    s_nop 1
    v_add_f32_dpp v104, v104, v104 row_ror:2 row_mask:0xf bank_mask:0xf
    s_nop 1
    v_add_f32_dpp v104, v104, v104 row_ror:1 row_mask:0xf bank_mask:0xf
    s_nop 1
    v_add_f32_dpp v104, v104, v104 row_bcast:15 row_mask:0xa bank_mask:0xf
    s_nop 1
    v_add_f32_dpp v104, v104, v104 row_bcast:31 row_mask:0xc bank_mask:0xf
    s_nop 0
    v_readlane_b32 s37, v104, 63
    s_nop 1
    v_mov_b32 v104, s37
    v_mov_b32 v105, s36
    v_cvt_pk_bf16_f32 v104, v104, v104
    v_lshlrev_b32 v104, 16, v104
    v_cvt_pk_bf16_f32 v105, v105, v105
    v_lshlrev_b32 v105, 16, v105
    v_add_f32 v104, 0x3727c5ac, v104
    v_cvt_pk_bf16_f32 v104, v104, v104
    v_lshlrev_b32 v104, 16, v104
    v_sqrt_f32 v104, v104
    s_nop 0
    v_cvt_pk_bf16_f32 v104, v104, v104
    v_lshlrev_b32 v104, 16, v104
    v_rcp_f32 v104, v104
    v_sub_f32 v106, v96, v105
    v_sub_f32 v107, v97, v105
    v_sub_f32 v108, v98, v105
    v_sub_f32 v109, v99, v105
    v_sub_f32 v110, v100, v105
    v_sub_f32 v111, v101, v105
    v_sub_f32 v112, v102, v105
    v_sub_f32 v113, v103, v105
    v_cvt_pk_bf16_f32 v12, v106, v107
    v_cvt_pk_bf16_f32 v13, v108, v109
    v_cvt_pk_bf16_f32 v14, v110, v111
    v_cvt_pk_bf16_f32 v15, v112, v113
    v_lshlrev_b32 v106, 16, v12
    v_and_b32 v107, 0xffff0000, v12
    v_lshlrev_b32 v108, 16, v13
    v_and_b32 v109, 0xffff0000, v13
    v_lshlrev_b32 v110, 16, v14
    v_and_b32 v111, 0xffff0000, v14
    v_lshlrev_b32 v112, 16, v15
    v_and_b32 v113, 0xffff0000, v15
    v_mul_f32 v106, v106, v104
    v_mul_f32 v107, v107, v104
    v_mul_f32 v108, v108, v104
    v_mul_f32 v109, v109, v104
    v_mul_f32 v110, v110, v104
    v_mul_f32 v111, v111, v104
    v_mul_f32 v112, v112, v104
    v_mul_f32 v113, v113, v104
    v_cvt_pk_bf16_f32 v12, v106, v107
    v_cvt_pk_bf16_f32 v13, v108, v109
    v_cvt_pk_bf16_f32 v14, v110, v111
    v_cvt_pk_bf16_f32 v15, v112, v113
    s_mov_b32 s34, 0x01000100
    s_mov_b32 s35, 0x03020302
    v_perm_b32 v96, v12, v12, s34
    v_perm_b32 v97, v12, v12, s35
    v_perm_b32 v98, v13, v13, s34
    v_perm_b32 v99, v13, v13, s35
    v_perm_b32 v100, v14, v14, s34
    v_perm_b32 v101, v14, v14, s35
    v_perm_b32 v102, v15, v15, s34
    v_perm_b32 v103, v15, v15, s35
    v_lshlrev_b32 v3, 5, v0
    ds_write_b128 v3, v[96:99] offset:7168
    ds_write_b128 v3, v[100:103] offset:7184
    v_lshlrev_b32 v3, 2, v10
    ds_read_b32 v104, v3 offset:7168
    ds_read_b32 v105, v3 offset:7200
    ds_read_b32 v106, v3 offset:7232
    ds_read_b32 v107, v3 offset:7264
    ds_read_b32 v108, v3 offset:7296
    ds_read_b32 v109, v3 offset:7328
    ds_read_b32 v110, v3 offset:7360
    ds_read_b32 v111, v3 offset:7392
    s_waitcnt lgkmcnt(0)
    s_add_u32 s33, s33, 0x9e3779b9
    v_mov_b32 v9, s33
    s_xor_b32 s58, s33, s49
    v_mov_b32 v155, s58
    v_and_b32 v80, v104, v4
    v_and_b32 v81, v104, v5
    v_and_b32 v82, v104, v6
    v_and_b32 v83, v104, v7
    s_waitcnt vmcnt(9)
    s_nop 0
    v_mfma_f32_16x16x32_bf16 v[96:99], v[80:83], v[16:19], 0
    v_and_b32 v84, v105, v4
    v_and_b32 v85, v105, v5
    v_and_b32 v86, v105, v6
    v_and_b32 v87, v105, v7
    s_waitcnt vmcnt(8)
    s_nop 0
    v_mfma_f32_16x16x32_bf16 v[96:99], v[84:87], v[20:23], v[96:99]
    v_and_b32 v88, v106, v4
    v_and_b32 v89, v106, v5
    v_and_b32 v90, v106, v6
    v_and_b32 v91, v106, v7
    s_waitcnt vmcnt(7)
    s_nop 0
    v_mfma_f32_16x16x32_bf16 v[96:99], v[88:91], v[24:27], v[96:99]
    v_and_b32 v92, v107, v4
    v_and_b32 v93, v107, v5
    v_and_b32 v94, v107, v6
    v_and_b32 v95, v107, v7
    s_waitcnt vmcnt(6)
    s_nop 0
    v_mfma_f32_16x16x32_bf16 v[96:99], v[92:95], v[28:31], v[96:99]
    v_and_b32 v80, v108, v4
    v_and_b32 v81, v108, v5
    v_and_b32 v82, v108, v6
    v_and_b32 v83, v108, v7
    s_waitcnt vmcnt(5)
    s_nop 0
    v_mfma_f32_16x16x32_bf16 v[96:99], v[80:83], v[32:35], v[96:99]
    v_and_b32 v84, v109, v4
    v_and_b32 v85, v109, v5
    v_and_b32 v86, v109, v6
    v_and_b32 v87, v109, v7
    s_waitcnt vmcnt(4)
    s_nop 0
    v_mfma_f32_16x16x32_bf16 v[96:99], v[84:87], v[36:39], v[96:99]
    v_and_b32 v88, v110, v4
    v_and_b32 v89, v110, v5
    v_and_b32 v90, v110, v6
    v_and_b32 v91, v110, v7
    s_waitcnt vmcnt(3)
    s_nop 0
    v_mfma_f32_16x16x32_bf16 v[96:99], v[88:91], v[40:43], v[96:99]
    v_and_b32 v92, v111, v4
    v_and_b32 v93, v111, v5
    v_and_b32 v94, v111, v6
    v_and_b32 v95, v111, v7
    s_waitcnt vmcnt(2)
    s_nop 0
    v_mfma_f32_16x16x32_bf16 v[96:99], v[92:95], v[44:47], v[96:99]
    s_lshl_b32 s34, s46, 11
    s_lshl_b32 s35, s47, 8
    s_add_u32 s35, s35, s34
    s_add_u32 s35, s35, 1245184
    v_lshlrev_b32 v3, 5, v1
    v_lshl_add_u32 v3, v2, 4, v3
    v_add_u32 v10, s35, v3
    s_nop 0
    v_mov_b32_dpp v100, v96 row_ror:8 row_mask:0xf bank_mask:0xf
    v_mov_b32_dpp v101, v97 row_ror:8 row_mask:0xf bank_mask:0xf
    v_mov_b32_dpp v102, v98 row_ror:8 row_mask:0xf bank_mask:0xf
    v_mov_b32_dpp v103, v99 row_ror:8 row_mask:0xf bank_mask:0xf
    v_permlane32_swap_b32 v100, v104
    v_permlane32_swap_b32 v101, v105
    v_permlane32_swap_b32 v102, v106
    v_permlane32_swap_b32 v103, v107
    v_add_f32 v96, v96, v104
    v_add_f32 v97, v97, v105
    v_add_f32 v98, v98, v106
    v_add_f32 v99, v99, v107
    v_perm_b32 v96, v96, v155, s52
    v_perm_b32 v97, v97, v155, s53
    v_perm_b32 v98, v98, v155, s54
    v_perm_b32 v99, v99, v155, s55
    s_mov_b64 exec, 0x00ff00ff
    global_store_dwordx4 v10, v[96:99], s[28:29]
    s_mov_b64 exec, -1
    s_branch L_mt2
L_mt_no1b:
    s_waitcnt lgkmcnt(0)
    s_add_u32 s33, s33, 0x9e3779b9
    v_mov_b32 v9, s33
    s_xor_b32 s58, s33, s49
    v_mov_b32 v155, s58
L_mt2:
    s_nop 1
    v_lshlrev_b32 v11, 3, v2
    v_lshrrev_b32 v11, v11, s58
    v_and_b32 v11, 0xff, v11
    v_lshlrev_b32 v3, 10, v2
    v_lshl_add_u32 v8, v1, 4, v3
    s_lshl_b32 s36, s39, 8
    v_add_u32 v8, s36, v8
    v_mov_b32 v144, 0
    v_mov_b32 v145, 0
    v_mov_b32 v146, 0
    v_mov_b32 v147, 0
    v_mov_b32 v148, 0
    v_mov_b32 v149, 0
    v_mov_b32 v150, 0
    v_mov_b32 v151, 0
    s_min_u32 s35, s41, 42
    s_lshl_b32 s35, s35, 15
    v_add_u32 v15, s35, v8
    s_cmp_lg_u32 s41, 43
    s_cbranch_scc1 L_mt2b
    v_xor_b32 v10, 1048576, v10
    v_perm_b32 v96, v96, v9, s52
    v_perm_b32 v97, v97, v9, s53
    v_perm_b32 v98, v98, v9, s54
    v_perm_b32 v99, v99, v9, s55
    s_mov_b64 exec, 0x00ff00ff
    global_store_dwordx4 v10, v[96:99], s[28:29] sc1
    s_mov_b64 exec, -1
L_mt2b:
    s_cmp_ge_u32 s41, 43
    s_cbranch_scc1 L_mt3
    v_and_b32 v3, 7, v1
    v_lshl_add_u32 v14, v3, 2, v2
    s_lshl_b32 s34, s41, 5
    v_add_u32 v13, s34, v14
    v_lshlrev_b32 v13, 1, v13
    global_load_ushort v12, v13, s[18:19] nt
    s_lshr_b32 s35, s41, 1
    s_lshl_b32 s35, s35, 11
    s_and_b32 s34, s41, 1
    s_lshl_b32 s34, s34, 7
    s_add_u32 s35, s35, s34
    s_add_u32 s35, s35, 1245184
    v_lshlrev_b32 v14, 2, v14
    v_lshrrev_b32 v3, 3, v1
    v_lshl_add_u32 v14, v3, 8, v14
    v_add_u32 v14, s35, v14
    s_mov_b32 s40, 0
L_hg:
    s_sleep 2
    v_mov_b32 v3, 0
    ds_read_b32 v3, v3 offset:12
    s_add_u32 s40, s40, 1
    s_waitcnt lgkmcnt(0)
    v_readfirstlane_b32 s36, v3
    s_cmp_ge_u32 s40, 16777216
    s_cbranch_scc1 L_hg_x
    s_cmp_lt_u32 s36, 2
    s_cbranch_scc1 L_hg
L_hg_x:
    s_mov_b32 s40, 0
    s_mov_b64 s[76:77], -1
    s_mov_b64 s[78:79], -1
    s_mov_b64 s[80:81], -1
    s_mov_b64 s[82:83], -1
L_ph:
    s_mov_b64 exec, s[76:77]
    global_load_dword v16, v14, s[28:29] offset:0 sc1
    s_mov_b64 exec, s[78:79]
    global_load_dword v17, v14, s[28:29] offset:512 sc1
    s_mov_b64 exec, s[80:81]
    global_load_dword v18, v14, s[28:29] offset:1024 sc1
    s_mov_b64 exec, s[82:83]
    global_load_dword v19, v14, s[28:29] offset:1536 sc1
    s_mov_b64 exec, -1
L_ph_c:
L_ph_s:
    s_add_u32 s40, s40, 1
    s_waitcnt vmcnt(3)
    v_cmp_ne_u32_sdwa vcc, v16, v11 src0_sel:BYTE_0 src1_sel:DWORD
    s_nop 0
    s_cmp_lg_u64 vcc, 0
    s_cselect_b64 s[76:77], s[76:77], 0
    s_waitcnt vmcnt(2)
    v_cmp_ne_u32_sdwa vcc, v17, v11 src0_sel:BYTE_0 src1_sel:DWORD
    s_nop 0
    s_cmp_lg_u64 vcc, 0
    s_cselect_b64 s[78:79], s[78:79], 0
    s_waitcnt vmcnt(1)
    v_cmp_ne_u32_sdwa vcc, v18, v11 src0_sel:BYTE_0 src1_sel:DWORD
    s_nop 0
    s_cmp_lg_u64 vcc, 0
    s_cselect_b64 s[80:81], s[80:81], 0
    s_waitcnt vmcnt(0)
    v_cmp_ne_u32_sdwa vcc, v19, v11 src0_sel:BYTE_0 src1_sel:DWORD
    s_nop 0
    s_cmp_lg_u64 vcc, 0
    s_cselect_b64 s[82:83], s[82:83], 0
    s_or_b64 s[34:35], s[76:77], s[78:79]
    s_or_b64 s[34:35], s[34:35], s[80:81]
    s_or_b64 s[34:35], s[34:35], s[82:83]
    s_cbranch_scc0 L_ph_x
    s_add_u32 s34, s40, 1
    s_and_b32 s35, s34, 6
    s_cbranch_scc1 L_hf
    v_xor_b32 v14, 1048576, v14
    v_xor_b32 v11, s48, v11
    s_bitcmp1_b32 s34, 0
    s_cbranch_scc1 L_hf
    v_xor_b32 v3, 1048576, v10
    v_perm_b32 v96, v96, v9, s52
    v_perm_b32 v97, v97, v9, s53
    v_perm_b32 v98, v98, v9, s54
    v_perm_b32 v99, v99, v9, s55
    s_mov_b64 exec, 0x00ff00ff
    global_store_dwordx4 v3, v[96:99], s[28:29] sc1
    s_mov_b64 exec, -1
L_hf:
    s_cmp_lt_u32 s40, 1048576
    s_cbranch_scc1 L_ph
L_ph_x:
    v_lshlrev_b32 v11, 3, v2
    v_lshrrev_b32 v11, v11, s58
    v_and_b32 v11, 0xff, v11
    v_and_b32 v16, 0xffffff00, v16
    v_and_b32 v17, 0xffffff00, v17
    v_and_b32 v18, 0xffffff00, v18
    v_and_b32 v19, 0xffffff00, v19
    v_add_f32 v16, v16, v17
    v_add_f32 v18, v18, v19
    v_add_f32 v16, v16, v18
    s_nop 1
    v_add_f32_dpp v16, v16, v16 row_ror:8 row_mask:0xf bank_mask:0xf
    v_cvt_pk_bf16_f32 v16, v16, v16
    v_lshlrev_b32 v16, 16, v16
    v_lshlrev_b32 v12, 16, v12
    v_add_f32 v16, v16, v12
    v_cvt_pk_bf16_f32 v16, v16, v16
    v_lshlrev_b32 v16, 16, v16
    v_mul_f32 v17, v16, v16
    v_mul_f32 v17, 0x3d372713, v17
    v_fma_f32 v17, v17, v16, v16
    v_mul_f32 v17, 0xc0135761, v17
    v_exp_f32 v17, v17
    s_nop 0
    v_add_f32 v17, 1.0, v17
    v_rcp_f32 v17, v17
    s_nop 0
    v_mul_f32 v16, v16, v17
    v_cvt_pk_bf16_f32 v16, v16, v16
    v_and_b32 v3, 3, v1
    v_lshlrev_b32 v3, 1, v3
    v_lshrrev_b32 v17, 3, v1
    v_add_u32 v3, v3, v17
    v_lshl_add_u32 v3, v2, 4, v3
    v_lshlrev_b32 v3, 2, v3
    ds_bpermute_b32 v16, v3, v16
    s_waitcnt lgkmcnt(0)
    v_and_b32_dpp v112, v16, v4 quad_perm:[0,0,0,0] row_mask:0xf bank_mask:0xf
    v_and_b32_dpp v113, v16, v5 quad_perm:[0,0,0,0] row_mask:0xf bank_mask:0xf
    v_and_b32_dpp v114, v16, v6 quad_perm:[0,0,0,0] row_mask:0xf bank_mask:0xf
    v_and_b32_dpp v115, v16, v7 quad_perm:[0,0,0,0] row_mask:0xf bank_mask:0xf
    v_and_b32_dpp v116, v16, v4 quad_perm:[1,1,1,1] row_mask:0xf bank_mask:0xf
    v_and_b32_dpp v117, v16, v5 quad_perm:[1,1,1,1] row_mask:0xf bank_mask:0xf
    v_and_b32_dpp v118, v16, v6 quad_perm:[1,1,1,1] row_mask:0xf bank_mask:0xf
    v_and_b32_dpp v119, v16, v7 quad_perm:[1,1,1,1] row_mask:0xf bank_mask:0xf
    v_and_b32_dpp v120, v16, v4 quad_perm:[2,2,2,2] row_mask:0xf bank_mask:0xf
    v_and_b32_dpp v121, v16, v5 quad_perm:[2,2,2,2] row_mask:0xf bank_mask:0xf
    v_and_b32_dpp v122, v16, v6 quad_perm:[2,2,2,2] row_mask:0xf bank_mask:0xf
    v_and_b32_dpp v123, v16, v7 quad_perm:[2,2,2,2] row_mask:0xf bank_mask:0xf
    v_and_b32_dpp v124, v16, v4 quad_perm:[3,3,3,3] row_mask:0xf bank_mask:0xf
    v_and_b32_dpp v125, v16, v5 quad_perm:[3,3,3,3] row_mask:0xf bank_mask:0xf
    v_and_b32_dpp v126, v16, v6 quad_perm:[3,3,3,3] row_mask:0xf bank_mask:0xf
    v_and_b32_dpp v127, v16, v7 quad_perm:[3,3,3,3] row_mask:0xf bank_mask:0xf
L_mt3:
    s_nop 1
    s_lshr_b32 s38, s32, 2
    s_lshl_b32 s34, s31, 1
    s_add_u32 s38, s38, s34
    s_lshl_b32 s35, s38, 16
    v_add_u32 v10, s35, v8
    s_lshl_b32 s34, s39, 15
    s_lshl_b32 s35, s38, 5
    s_add_u32 s34, s34, s35
    s_add_u32 s34, s34, 524288
    v_lshlrev_b32 v13, 11, v1
    v_lshl_add_u32 v13, v2, 4, v13
    v_add_u32 v13, s34, v13
    s_lshl_b32 s34, s31, 12
    s_add_u32 s34, s34, 1310720
    s_lshl_b32 s35, s32, 9
    s_add_u32 s35, s35, s34
    v_lshlrev_b32 v8, 2, v0
    v_add_u32 v14, s35, v8
    s_and_b32 s35, s38, 1
    s_lshl_b32 s35, s35, 8
    s_add_u32 s35, s35, s34
    v_and_b32 v3, 7, v1
    v_lshlrev_b32 v3, 5, v3
    v_lshrrev_b32 v12, 3, v1
    v_lshl_add_u32 v3, v12, 4, v3
    v_lshl_add_u32 v3, v2, 2, v3
    v_add_u32 v152, s35, v3
    s_lshl_b32 s34, s31, 7
    s_add_u32 s34, s34, 1052672
    v_and_b32 v12, 7, v1
    v_lshlrev_b32 v12, 4, v12
    v_add_u32 v12, s34, v12
    s_lshl_b32 s35, s32, 4
    s_add_u32 s34, s34, s35
    v_mov_b32 v153, s34
    v_and_b32 v156, 3, v0
    v_or_b32 v156, 0x07060500, v156
    v_mov_b32 v2, s58
    v_mov_b32 v3, s58
    v_mov_b32 v157, 0
    v_mov_b32 v158, 1
    v_mov_b32 v154, v15
    v_mov_b32 v167, v10
    s_mov_b32 s40, 0
L_wi:
    s_sleep 2
    ds_read_b32 v10, v157 offset:12
    s_add_u32 s40, s40, 1
    s_waitcnt lgkmcnt(0)
    v_readfirstlane_b32 s36, v10
    s_cmp_ge_u32 s40, 16777216
    s_cbranch_scc1 L_wi_x
    s_cmp_lt_u32 s36, 8
    s_cbranch_scc1 L_wi
L_wi_x:
    s_cmp_ge_u32 s41, 43
    s_cbranch_scc1 L_mt4_1
    global_load_dwordx4 v[80:83], v154, s[20:21] nt
    v_add_u32 v154, 4096, v154
    global_load_dwordx4 v[84:87], v154, s[20:21] nt
    v_add_u32 v154, 4096, v154
    global_load_dwordx4 v[88:91], v154, s[20:21] nt
    v_add_u32 v154, 4096, v154
    global_load_dwordx4 v[92:95], v154, s[20:21] nt
    v_add_u32 v154, 4096, v154
    global_load_dwordx4 v[96:99], v154, s[20:21] nt
    v_add_u32 v154, 4096, v154
    global_load_dwordx4 v[100:103], v154, s[20:21] nt
    v_add_u32 v154, 4096, v154
    global_load_dwordx4 v[104:107], v154, s[20:21] nt
    v_add_u32 v154, 4096, v154
    global_load_dwordx4 v[108:111], v154, s[20:21] nt
L_mt4_1:
    s_mov_b32 s40, 0
L_wa:
    ds_read_b32 v10, v157 offset:4
    s_add_u32 s40, s40, 1
    s_waitcnt lgkmcnt(0)
    v_readfirstlane_b32 s36, v10
    s_cmp_ge_u32 s40, 16777216
    s_cbranch_scc1 L_wa_x
    s_cmp_lt_u32 s36, 8
    s_cbranch_scc1 L_wa
L_wa_x:
    ds_read_b128 v[128:131], v157 offset:512
    ds_read_b128 v[132:135], v157 offset:528
    ds_read_b128 v[136:139], v157 offset:544
    ds_read_b128 v[140:143], v157 offset:560
    s_waitcnt lgkmcnt(0)
    v_max3_f32 v0, v128, v130, v132
    v_max3_f32 v0, v0, v134, v136
    v_max3_f32 v0, v0, v138, v140
    v_max_f32 v0, v0, v142
    v_sub_f32 v159, v128, v0
    v_sub_f32 v160, v130, v0
    v_sub_f32 v161, v132, v0
    v_sub_f32 v162, v134, v0
    v_sub_f32 v163, v136, v0
    v_sub_f32 v164, v138, v0
    v_sub_f32 v165, v140, v0
    v_sub_f32 v166, v142, v0
    v_exp_f32 v159, v159
    v_exp_f32 v160, v160
    v_exp_f32 v161, v161
    v_exp_f32 v162, v162
    v_exp_f32 v163, v163
    v_exp_f32 v164, v164
    v_exp_f32 v165, v165
    v_exp_f32 v166, v166
    v_mul_f32 v1, v159, v129
    v_fmac_f32 v1, v160, v131
    v_fmac_f32 v1, v161, v133
    v_fmac_f32 v1, v162, v135
    v_fmac_f32 v1, v163, v137
    v_fmac_f32 v1, v164, v139
    v_fmac_f32 v1, v165, v141
    v_fmac_f32 v1, v166, v143
    s_mov_b64 exec, 1
    global_store_dwordx4 v153, v[0:3], s[28:29]
    s_mov_b64 exec, -1
    s_mov_b64 s[76:77], -1
    s_mov_b64 s[78:79], -1
    s_mov_b64 s[80:81], -1
    s_mov_b64 s[82:83], -1
    s_mov_b64 s[84:85], -1
    s_mov_b64 s[86:87], -1
    s_mov_b64 s[88:89], -1
    s_mov_b64 s[90:91], -1
    s_mov_b64 s[92:93], -1
    s_mov_b32 s40, 0
L_wb:
    ds_read_b32 v10, v157 offset:8
    s_add_u32 s40, s40, 1
    s_waitcnt lgkmcnt(0)
    v_readfirstlane_b32 s36, v10
    s_cmp_ge_u32 s40, 16777216
    s_cbranch_scc1 L_wb_x
    s_cmp_lt_u32 s36, 8
    s_cbranch_scc1 L_wb
L_wb_x:
    s_mov_b32 s40, 0
    ds_read2st64_b32 v[128:129], v8 offset0:4 offset1:5
    ds_read2st64_b32 v[130:131], v8 offset0:6 offset1:7
    ds_read2st64_b32 v[132:133], v8 offset0:8 offset1:9
    ds_read2st64_b32 v[134:135], v8 offset0:10 offset1:11
    ds_read2st64_b32 v[136:137], v8 offset0:12 offset1:13
    ds_read2st64_b32 v[138:139], v8 offset0:14 offset1:15
    ds_read2st64_b32 v[140:141], v8 offset0:16 offset1:17
    ds_read2st64_b32 v[142:143], v8 offset0:18 offset1:19
    s_waitcnt lgkmcnt(7)
    v_mul_f32 v10, v159, v128
    v_mul_f32 v15, v159, v129
    s_waitcnt lgkmcnt(6)
    v_fmac_f32 v10, v160, v130
    v_fmac_f32 v15, v160, v131
    s_waitcnt lgkmcnt(5)
    v_fmac_f32 v10, v161, v132
    v_fmac_f32 v15, v161, v133
    s_waitcnt lgkmcnt(4)
    v_fmac_f32 v10, v162, v134
    v_fmac_f32 v15, v162, v135
    s_waitcnt lgkmcnt(3)
    v_fmac_f32 v10, v163, v136
    v_fmac_f32 v15, v163, v137
    s_waitcnt lgkmcnt(2)
    v_fmac_f32 v10, v164, v138
    v_fmac_f32 v15, v164, v139
    s_waitcnt lgkmcnt(1)
    v_fmac_f32 v10, v165, v140
    v_fmac_f32 v15, v165, v141
    s_waitcnt lgkmcnt(0)
    v_fmac_f32 v10, v166, v142
    v_fmac_f32 v15, v166, v143
    v_perm_b32 v10, v10, v155, v156
    v_perm_b32 v15, v15, v155, v156
    global_store_dword v14, v10, s[28:29]
    global_store_dword v14, v15, s[28:29] offset:256
    global_load_dwordx4 v[136:139], v12, s[28:29] sc1
    global_load_dword v128, v152, s[28:29] offset:0 sc1
    global_load_dword v129, v152, s[28:29] offset:512 sc1
    global_load_dword v130, v152, s[28:29] offset:1024 sc1
    global_load_dword v131, v152, s[28:29] offset:1536 sc1
    global_load_dword v132, v152, s[28:29] offset:2048 sc1
    global_load_dword v133, v152, s[28:29] offset:2560 sc1
    global_load_dword v134, v152, s[28:29] offset:3072 sc1
    global_load_dword v135, v152, s[28:29] offset:3584 sc1
    global_load_dwordx4 v[16:19], v167, s[12:13] nt
    v_add_u32 v167, 4096, v167
    global_load_dwordx4 v[20:23], v167, s[12:13] nt
    v_add_u32 v167, 4096, v167
    global_load_dwordx4 v[24:27], v167, s[12:13] nt
    v_add_u32 v167, 4096, v167
    global_load_dwordx4 v[28:31], v167, s[12:13] nt
    v_add_u32 v167, 4096, v167
    global_load_dwordx4 v[32:35], v167, s[12:13] nt
    v_add_u32 v167, 4096, v167
    global_load_dwordx4 v[36:39], v167, s[12:13] nt
    v_add_u32 v167, 4096, v167
    global_load_dwordx4 v[40:43], v167, s[12:13] nt
    v_add_u32 v167, 4096, v167
    global_load_dwordx4 v[44:47], v167, s[12:13] nt
    v_add_u32 v167, 4096, v167
    global_load_dwordx4 v[48:51], v167, s[12:13] nt
    v_add_u32 v167, 4096, v167
    global_load_dwordx4 v[52:55], v167, s[12:13] nt
    v_add_u32 v167, 4096, v167
    global_load_dwordx4 v[56:59], v167, s[12:13] nt
    v_add_u32 v167, 4096, v167
    global_load_dwordx4 v[60:63], v167, s[12:13] nt
    v_add_u32 v167, 4096, v167
    global_load_dwordx4 v[64:67], v167, s[12:13] nt
    v_add_u32 v167, 4096, v167
    global_load_dwordx4 v[68:71], v167, s[12:13] nt
    v_add_u32 v167, 4096, v167
    global_load_dwordx4 v[72:75], v167, s[12:13] nt
    v_add_u32 v167, 4096, v167
    global_load_dwordx4 v[76:79], v167, s[12:13] nt
    s_cmp_ge_u32 s41, 43
    s_cbranch_scc1 L_mt5
    s_waitcnt vmcnt(28)
    v_mfma_f32_16x16x32_bf16 v[144:147], v[112:115], v[80:83], v[144:147]
    v_mfma_f32_16x16x32_bf16 v[148:151], v[112:115], v[84:87], v[148:151]
    v_mfma_f32_16x16x32_bf16 v[144:147], v[116:119], v[88:91], v[144:147]
    v_mfma_f32_16x16x32_bf16 v[148:151], v[116:119], v[92:95], v[148:151]
    v_mfma_f32_16x16x32_bf16 v[144:147], v[120:123], v[96:99], v[144:147]
    v_mfma_f32_16x16x32_bf16 v[148:151], v[120:123], v[100:103], v[148:151]
    v_mfma_f32_16x16x32_bf16 v[144:147], v[124:127], v[104:107], v[144:147]
    v_mfma_f32_16x16x32_bf16 v[148:151], v[124:127], v[108:111], v[148:151]
L_mt5:
    s_waitcnt vmcnt(24)
    v_cmp_ne_u32 vcc, s58, v138
    v_max_f32_dpp v159, v136, v136 quad_perm:[1,0,3,2] row_mask:0xf bank_mask:0xf
    s_nop 1
    v_max_f32_dpp v159, v159, v159 quad_perm:[2,3,0,1] row_mask:0xf bank_mask:0xf
    s_nop 1
    v_max_f32_dpp v159, v159, v159 row_half_mirror row_mask:0xf bank_mask:0xf
    v_sub_f32 v159, v136, v159
    v_exp_f32 v159, v159
    s_nop 0
    v_mul_f32 v160, v159, v137
    s_nop 1
    v_add_f32_dpp v160, v160, v160 quad_perm:[1,0,3,2] row_mask:0xf bank_mask:0xf
    s_nop 1
    v_add_f32_dpp v160, v160, v160 quad_perm:[2,3,0,1] row_mask:0xf bank_mask:0xf
    s_nop 1
    v_add_f32_dpp v160, v160, v160 row_half_mirror row_mask:0xf bank_mask:0xf
    v_rcp_f32 v160, v160
    s_nop 0
    v_mul_f32 v159, v159, v160
    s_and_b64 s[76:77], s[76:77], vcc
    s_waitcnt vmcnt(22)
    v_xor_b32 v161, v128, v11
    v_xor_b32 v162, v129, v11
    s_waitcnt vmcnt(20)
    v_bitop3_b32 v161, v161, v130, v11 bitop3:0xf6
    v_bitop3_b32 v162, v162, v131, v11 bitop3:0xf6
    s_waitcnt vmcnt(18)
    v_bitop3_b32 v161, v161, v132, v11 bitop3:0xf6
    v_bitop3_b32 v162, v162, v133, v11 bitop3:0xf6
    s_waitcnt vmcnt(16)
    v_bitop3_b32 v161, v161, v134, v11 bitop3:0xf6
    v_bitop3_b32 v162, v162, v135, v11 bitop3:0xf6
    v_or_b32 v161, v161, v162
    v_cmp_ne_u32_sdwa vcc, v161, v157 src0_sel:BYTE_0 src1_sel:DWORD
    s_nop 0
    s_or_b64 s[34:35], vcc, s[76:77]
    s_cbranch_scc0 L_po_x
    s_branch L_po_s
L_po:
    s_mov_b64 exec, s[76:77]
    global_load_dwordx4 v[136:139], v12, s[28:29] sc1
    s_mov_b64 exec, s[78:79]
    global_load_dword v128, v152, s[28:29] offset:0 sc1
    s_mov_b64 exec, s[80:81]
    global_load_dword v129, v152, s[28:29] offset:512 sc1
    s_mov_b64 exec, s[82:83]
    global_load_dword v130, v152, s[28:29] offset:1024 sc1
    s_mov_b64 exec, s[84:85]
    global_load_dword v131, v152, s[28:29] offset:1536 sc1
    s_mov_b64 exec, s[86:87]
    global_load_dword v132, v152, s[28:29] offset:2048 sc1
    s_mov_b64 exec, s[88:89]
    global_load_dword v133, v152, s[28:29] offset:2560 sc1
    s_mov_b64 exec, s[90:91]
    global_load_dword v134, v152, s[28:29] offset:3072 sc1
    s_mov_b64 exec, s[92:93]
    global_load_dword v135, v152, s[28:29] offset:3584 sc1
    s_mov_b64 exec, -1
L_po_c:
    s_cmp_eq_u64 s[76:77], 0
    s_cbranch_scc1 L_mlok
    s_waitcnt vmcnt(8)
    v_cmp_ne_u32 vcc, s58, v138
    v_max_f32_dpp v159, v136, v136 quad_perm:[1,0,3,2] row_mask:0xf bank_mask:0xf
    s_nop 1
    v_max_f32_dpp v159, v159, v159 quad_perm:[2,3,0,1] row_mask:0xf bank_mask:0xf
    s_nop 1
    v_max_f32_dpp v159, v159, v159 row_half_mirror row_mask:0xf bank_mask:0xf
    v_sub_f32 v159, v136, v159
    v_exp_f32 v159, v159
    s_nop 0
    v_mul_f32 v160, v159, v137
    s_nop 1
    v_add_f32_dpp v160, v160, v160 quad_perm:[1,0,3,2] row_mask:0xf bank_mask:0xf
    s_nop 1
    v_add_f32_dpp v160, v160, v160 quad_perm:[2,3,0,1] row_mask:0xf bank_mask:0xf
    s_nop 1
    v_add_f32_dpp v160, v160, v160 row_half_mirror row_mask:0xf bank_mask:0xf
    v_rcp_f32 v160, v160
    s_nop 0
    v_mul_f32 v159, v159, v160
    s_and_b64 s[76:77], s[76:77], vcc
L_mlok:
    s_waitcnt vmcnt(6)
    v_xor_b32 v161, v128, v11
    v_xor_b32 v162, v129, v11
    s_waitcnt vmcnt(4)
    v_bitop3_b32 v161, v161, v130, v11 bitop3:0xf6
    v_bitop3_b32 v162, v162, v131, v11 bitop3:0xf6
    s_waitcnt vmcnt(2)
    v_bitop3_b32 v161, v161, v132, v11 bitop3:0xf6
    v_bitop3_b32 v162, v162, v133, v11 bitop3:0xf6
    s_waitcnt vmcnt(0)
    v_bitop3_b32 v161, v161, v134, v11 bitop3:0xf6
    v_bitop3_b32 v162, v162, v135, v11 bitop3:0xf6
    v_or_b32 v161, v161, v162
    v_cmp_ne_u32_sdwa vcc, v161, v157 src0_sel:BYTE_0 src1_sel:DWORD
    s_nop 0
    s_or_b64 s[34:35], vcc, s[76:77]
    s_cbranch_scc0 L_po_x
L_po_s:
    s_add_u32 s40, s40, 1
    v_cmp_ne_u32_sdwa vcc, v128, v11 src0_sel:BYTE_0 src1_sel:DWORD
    s_nop 0
    s_cmp_lg_u64 vcc, 0
    s_cselect_b64 s[78:79], s[78:79], 0
    v_cmp_ne_u32_sdwa vcc, v129, v11 src0_sel:BYTE_0 src1_sel:DWORD
    s_nop 0
    s_cmp_lg_u64 vcc, 0
    s_cselect_b64 s[80:81], s[80:81], 0
    v_cmp_ne_u32_sdwa vcc, v130, v11 src0_sel:BYTE_0 src1_sel:DWORD
    s_nop 0
    s_cmp_lg_u64 vcc, 0
    s_cselect_b64 s[82:83], s[82:83], 0
    v_cmp_ne_u32_sdwa vcc, v131, v11 src0_sel:BYTE_0 src1_sel:DWORD
    s_nop 0
    s_cmp_lg_u64 vcc, 0
    s_cselect_b64 s[84:85], s[84:85], 0
    v_cmp_ne_u32_sdwa vcc, v132, v11 src0_sel:BYTE_0 src1_sel:DWORD
    s_nop 0
    s_cmp_lg_u64 vcc, 0
    s_cselect_b64 s[86:87], s[86:87], 0
    v_cmp_ne_u32_sdwa vcc, v133, v11 src0_sel:BYTE_0 src1_sel:DWORD
    s_nop 0
    s_cmp_lg_u64 vcc, 0
    s_cselect_b64 s[88:89], s[88:89], 0
    v_cmp_ne_u32_sdwa vcc, v134, v11 src0_sel:BYTE_0 src1_sel:DWORD
    s_nop 0
    s_cmp_lg_u64 vcc, 0
    s_cselect_b64 s[90:91], s[90:91], 0
    v_cmp_ne_u32_sdwa vcc, v135, v11 src0_sel:BYTE_0 src1_sel:DWORD
    s_nop 0
    s_cmp_lg_u64 vcc, 0
    s_cselect_b64 s[92:93], s[92:93], 0
    s_or_b64 s[34:35], s[76:77], s[78:79]
    s_or_b64 s[34:35], s[34:35], s[80:81]
    s_or_b64 s[34:35], s[34:35], s[82:83]
    s_or_b64 s[34:35], s[34:35], s[84:85]
    s_or_b64 s[34:35], s[34:35], s[86:87]
    s_or_b64 s[34:35], s[34:35], s[88:89]
    s_or_b64 s[34:35], s[34:35], s[90:91]
    s_or_b64 s[34:35], s[34:35], s[92:93]
    s_cbranch_scc0 L_po_x
    s_add_u32 s34, s40, 1
    s_and_b32 s35, s34, 30
    s_cbranch_scc1 L_of
    v_xor_b32 v152, 1048576, v152
    v_xor_b32 v12, 1048576, v12
    v_xor_b32 v11, s48, v11
    s_xor_b32 s58, s58, s49
    s_bitcmp1_b32 s34, 0
    s_cbranch_scc1 L_of
    v_perm_b32 v140, v10, v9, v156
    v_perm_b32 v141, v15, v9, v156
    v_xor_b32 v142, 1048576, v14
    v_xor_b32 v143, 1048576, v153
    v_mov_b32 v2, s33
    global_store_dword v142, v140, s[28:29] sc1
    global_store_dword v142, v141, s[28:29] offset:256 sc1
    s_mov_b64 exec, 1
    global_store_dwordx4 v143, v[0:3], s[28:29] sc1
    s_mov_b64 exec, -1
L_of:
    s_cmp_lt_u32 s40, 1048576
    s_cbranch_scc1 L_po
L_po_x:
    v_and_b32 v128, 0xffffff00, v128
    v_and_b32 v129, 0xffffff00, v129
    v_and_b32 v130, 0xffffff00, v130
    v_mul_f32_dpp v165, v159, v128 row_newbcast:0 row_mask:0xf bank_mask:0xf
    v_and_b32 v131, 0xffffff00, v131
    v_mul_f32_dpp v166, v159, v129 row_newbcast:1 row_mask:0xf bank_mask:0xf
    v_and_b32 v132, 0xffffff00, v132
    v_fmac_f32_dpp v165, v159, v130 row_newbcast:2 row_mask:0xf bank_mask:0xf
    v_and_b32 v133, 0xffffff00, v133
    v_fmac_f32_dpp v166, v159, v131 row_newbcast:3 row_mask:0xf bank_mask:0xf
    v_and_b32 v134, 0xffffff00, v134
    v_fmac_f32_dpp v165, v159, v132 row_newbcast:4 row_mask:0xf bank_mask:0xf
    v_and_b32 v135, 0xffffff00, v135
    v_fmac_f32_dpp v166, v159, v133 row_newbcast:5 row_mask:0xf bank_mask:0xf
    v_fmac_f32_dpp v165, v159, v134 row_newbcast:6 row_mask:0xf bank_mask:0xf
    s_nop 0
    v_fmac_f32_dpp v166, v159, v135 row_newbcast:7 row_mask:0xf bank_mask:0xf
    v_add_f32 v165, v165, v166
    v_cvt_pk_bf16_f32 v163, v165, v165
    v_cvt_pk_bf16_f32 v164, v165, v165
    v_cvt_pk_bf16_f32 v165, v165, v165
    s_nop 1
    v_mov_b32_dpp v163, v165 row_shr:4 row_mask:0xf bank_mask:0xa
    v_mov_b32_dpp v164, v165 row_shl:4 row_mask:0xf bank_mask:0x5
    s_nop 0
    v_and_b32_dpp v128, v163, v4 quad_perm:[0,0,0,0] row_mask:0xf bank_mask:0xf
    v_and_b32_dpp v129, v163, v5 quad_perm:[0,0,0,0] row_mask:0xf bank_mask:0xf
    v_and_b32_dpp v130, v163, v6 quad_perm:[0,0,0,0] row_mask:0xf bank_mask:0xf
    v_and_b32_dpp v131, v163, v7 quad_perm:[0,0,0,0] row_mask:0xf bank_mask:0xf
    v_and_b32_dpp v132, v163, v4 quad_perm:[1,1,1,1] row_mask:0xf bank_mask:0xf
    v_and_b32_dpp v133, v163, v5 quad_perm:[1,1,1,1] row_mask:0xf bank_mask:0xf
    v_and_b32_dpp v134, v163, v6 quad_perm:[1,1,1,1] row_mask:0xf bank_mask:0xf
    v_and_b32_dpp v135, v163, v7 quad_perm:[1,1,1,1] row_mask:0xf bank_mask:0xf
    s_waitcnt vmcnt(14)
    v_mfma_f32_16x16x32_bf16 v[144:147], v[128:131], v[16:19], v[144:147]
    v_mfma_f32_16x16x32_bf16 v[148:151], v[128:131], v[20:23], v[148:151]
    v_and_b32_dpp v136, v163, v4 quad_perm:[2,2,2,2] row_mask:0xf bank_mask:0xf
    v_and_b32_dpp v137, v163, v5 quad_perm:[2,2,2,2] row_mask:0xf bank_mask:0xf
    v_and_b32_dpp v138, v163, v6 quad_perm:[2,2,2,2] row_mask:0xf bank_mask:0xf
    v_and_b32_dpp v139, v163, v7 quad_perm:[2,2,2,2] row_mask:0xf bank_mask:0xf
    s_waitcnt vmcnt(12)
    v_mfma_f32_16x16x32_bf16 v[144:147], v[132:135], v[24:27], v[144:147]
    v_mfma_f32_16x16x32_bf16 v[148:151], v[132:135], v[28:31], v[148:151]
    v_and_b32_dpp v140, v163, v4 quad_perm:[3,3,3,3] row_mask:0xf bank_mask:0xf
    v_and_b32_dpp v141, v163, v5 quad_perm:[3,3,3,3] row_mask:0xf bank_mask:0xf
    v_and_b32_dpp v142, v163, v6 quad_perm:[3,3,3,3] row_mask:0xf bank_mask:0xf
    v_and_b32_dpp v143, v163, v7 quad_perm:[3,3,3,3] row_mask:0xf bank_mask:0xf
    s_waitcnt vmcnt(10)
    v_mfma_f32_16x16x32_bf16 v[144:147], v[136:139], v[32:35], v[144:147]
    v_mfma_f32_16x16x32_bf16 v[148:151], v[136:139], v[36:39], v[148:151]
    v_and_b32_dpp v128, v164, v4 quad_perm:[0,0,0,0] row_mask:0xf bank_mask:0xf
    v_and_b32_dpp v129, v164, v5 quad_perm:[0,0,0,0] row_mask:0xf bank_mask:0xf
    v_and_b32_dpp v130, v164, v6 quad_perm:[0,0,0,0] row_mask:0xf bank_mask:0xf
    v_and_b32_dpp v131, v164, v7 quad_perm:[0,0,0,0] row_mask:0xf bank_mask:0xf
    s_waitcnt vmcnt(8)
    v_mfma_f32_16x16x32_bf16 v[144:147], v[140:143], v[40:43], v[144:147]
    v_mfma_f32_16x16x32_bf16 v[148:151], v[140:143], v[44:47], v[148:151]
    v_and_b32_dpp v132, v164, v4 quad_perm:[1,1,1,1] row_mask:0xf bank_mask:0xf
    v_and_b32_dpp v133, v164, v5 quad_perm:[1,1,1,1] row_mask:0xf bank_mask:0xf
    v_and_b32_dpp v134, v164, v6 quad_perm:[1,1,1,1] row_mask:0xf bank_mask:0xf
    v_and_b32_dpp v135, v164, v7 quad_perm:[1,1,1,1] row_mask:0xf bank_mask:0xf
    s_waitcnt vmcnt(6)
    v_mfma_f32_16x16x32_bf16 v[144:147], v[128:131], v[48:51], v[144:147]
    v_mfma_f32_16x16x32_bf16 v[148:151], v[128:131], v[52:55], v[148:151]
    v_and_b32_dpp v136, v164, v4 quad_perm:[2,2,2,2] row_mask:0xf bank_mask:0xf
    v_and_b32_dpp v137, v164, v5 quad_perm:[2,2,2,2] row_mask:0xf bank_mask:0xf
    v_and_b32_dpp v138, v164, v6 quad_perm:[2,2,2,2] row_mask:0xf bank_mask:0xf
    v_and_b32_dpp v139, v164, v7 quad_perm:[2,2,2,2] row_mask:0xf bank_mask:0xf
    s_waitcnt vmcnt(4)
    v_mfma_f32_16x16x32_bf16 v[144:147], v[132:135], v[56:59], v[144:147]
    v_mfma_f32_16x16x32_bf16 v[148:151], v[132:135], v[60:63], v[148:151]
    v_and_b32_dpp v140, v164, v4 quad_perm:[3,3,3,3] row_mask:0xf bank_mask:0xf
    v_and_b32_dpp v141, v164, v5 quad_perm:[3,3,3,3] row_mask:0xf bank_mask:0xf
    v_and_b32_dpp v142, v164, v6 quad_perm:[3,3,3,3] row_mask:0xf bank_mask:0xf
    v_and_b32_dpp v143, v164, v7 quad_perm:[3,3,3,3] row_mask:0xf bank_mask:0xf
    s_waitcnt vmcnt(2)
    v_mfma_f32_16x16x32_bf16 v[144:147], v[136:139], v[64:67], v[144:147]
    v_mfma_f32_16x16x32_bf16 v[148:151], v[136:139], v[68:71], v[148:151]
    s_waitcnt vmcnt(0)
    v_mfma_f32_16x16x32_bf16 v[144:147], v[140:143], v[72:75], v[144:147]
    v_mfma_f32_16x16x32_bf16 v[148:151], v[140:143], v[76:79], v[148:151]
    s_nop 7
    v_permlane32_swap_b32 v148, v100
    v_permlane32_swap_b32 v149, v101
    v_permlane32_swap_b32 v150, v102
    v_permlane32_swap_b32 v151, v103
    v_add_f32 v144, v144, v100
    v_add_f32 v145, v145, v101
    v_add_f32 v146, v146, v102
    v_add_f32 v147, v147, v103
    v_perm_b32 v144, v144, v9, s52
    v_perm_b32 v145, v145, v9, s53
    v_perm_b32 v146, v146, v9, s54
    v_perm_b32 v147, v147, v9, s55
    s_mov_b64 exec, 0xffffffff
    global_store_dwordx4 v13, v[144:147], s[28:29] sc1
    s_mov_b64 exec, -1
    s_mov_b64 exec, 1
    ds_add_u32 v157, v158 offset:8
L_end:
    s_endpgm
.section .rodata,"a"
.p2align 6
.amdhsa_kernel parallel_sum__sliding_block_cached__mixer_channel_mlp__decode_kernel
  .amdhsa_next_free_vgpr 168
  .amdhsa_next_free_sgpr 96
  .amdhsa_accum_offset 168
  .amdhsa_group_segment_fixed_size 0
  .amdhsa_kernarg_size 104
  .amdhsa_user_sgpr_count 2
  .amdhsa_user_sgpr_kernarg_segment_ptr 1
  .amdhsa_system_sgpr_workgroup_id_x 1
  .amdhsa_float_denorm_mode_32 3
.end_amdhsa_kernel
```
